```python
import torch

def _softmax(x, axis=-1):
    return torch.softmax(x, dim=axis)
def _gelu(x):
    return torch.nn.functional.gelu(x, approximate="tanh")
def _silu(x):
    return torch.nn.functional.silu(x)
def _sigmoid(x):
    return torch.sigmoid(x)
def _layernorm(x, axis=-1, eps=1e-5):
    m = x.mean(dim=axis, keepdim=True)
    v = x.var(dim=axis, keepdim=True, unbiased=False)
    return (x - m) / torch.sqrt(v + eps)
def _scatter_add(tgt, idx, src, axis=0):
    return tgt.clone().index_add_(axis, idx, src)
def _segment_sum(src, seg, n):
    out = torch.zeros((n,) + src.shape[1:], dtype=src.dtype)
    return out.index_add_(0, seg, src)
def _pad(x, pw):
    flat = tuple(v for pair in reversed(pw) for v in pair)
    return torch.nn.functional.pad(x, flat)

kernel_name = 'sequential_preLN__spectral_gfnet__glu_gated_swiglu__prompt'

def setup_inputs():

    _w = (lambda a: (lambda t: t.to(torch.bfloat16) if t.is_floating_point() else t)(torch.as_tensor(a)))
    def _A_setup():
        B, S, D = 1, 2048, 448
        Df = D // 2 + 1
        return {
            "x": _w((lambda *s: torch.randn(*s, dtype=torch.bfloat16) * 0.05)(B, S, D)),
            "w_r": _w((lambda *s: torch.randn(*s, dtype=torch.bfloat16) * 0.4)(S, Df) * 0.02),
            "w_i": _w((lambda *s: torch.randn(*s, dtype=torch.bfloat16) * 0.4)(S, Df) * 0.02),
        }
    _A_in = _A_setup()

    def _B_setup():
        B, S, D, F = 1, 2048, 448, 1792
        return {
            "x": _w((lambda *s: torch.randn(*s, dtype=torch.bfloat16) * 0.05)(B, S, D)),
            "w1": _w((lambda *s: torch.randn(*s, dtype=torch.bfloat16) * 0.2)(D, F) * (2.0 / D) ** 0.5),
            "w3": _w((lambda *s: torch.randn(*s, dtype=torch.bfloat16) * 0.2)(D, F) * (2.0 / D) ** 0.5),
            "w2": _w((lambda *s: torch.randn(*s, dtype=torch.bfloat16) * 0.2)(F, D) * (2.0 / F) ** 0.5),
        }
    _B_in = _B_setup()

    return {
        "A_x": _A_in["x"],
        "A_w_r": _A_in["w_r"],
        "A_w_i": _A_in["w_i"],
        "B_x": _B_in["x"],
        "B_w1": _B_in["w1"],
        "B_w3": _B_in["w3"],
        "B_w2": _B_in["w2"],
    }

def reference(A_x, A_w_r, A_w_i, B_x, B_w1, B_w3, B_w2):
    def _A_ref(x, w_r, w_i):
        B, S, D = x.shape
        X = (lambda x, axes=(-2,-1): torch.fft.rfft2(x.float(), dim=axes))(x, axes=(-2, -1))
        W = w_r + 1j * w_i
        X = X * W
        y = (lambda x, s, axes=(-2,-1): torch.fft.irfft2(x, s=s, dim=axes).to(torch.bfloat16))(X, (S, D), axes=(-2, -1))
        return y

    def _B_ref(x, w1, w3, w2):
        gate = torch.einsum("bsd,df->bsf", x, w1)
        up = torch.einsum("bsd,df->bsf", x, w3)
        h = _silu(gate) * up
        out = torch.einsum("bsf,fd->bsd", h, w2)
        return out

    x = A_x
    h = x + _A_ref(_layernorm(x, axis=-1), A_w_r, A_w_i)
    h2 = h + _B_ref(_layernorm(h, axis=-1), B_w1, B_w3, B_w2)
    return h2
```

```asm
; @launch grid=(256,1,1) block=(256,1,1) lds=122880
.amdgcn_target "amdgcn-amd-amdhsa--gfx950"
.text
.globl sequential_preLN__spectral_gfnet__glu_gated_swiglu__prompt_kernel
.p2align 8
.type sequential_preLN__spectral_gfnet__glu_gated_swiglu__prompt_kernel,@function
sequential_preLN__spectral_gfnet__glu_gated_swiglu__prompt_kernel:
    s_cmp_ge_u32 s2, 256
    s_cbranch_scc1 L_end
    s_load_dwordx16 s[64:79], s[0:1], 0
    s_load_dwordx4 s[80:83], s[0:1], 64
    s_memrealtime s[86:87]
    s_getpc_b64 s[52:53]
L_pc:
    s_lshr_b32 s54, s2, 3
    s_lshl_b32 s54, s54, 10
    s_cmp_ge_u32 s54, L_fin-L_pc-1024
    s_cbranch_scc1 Lcpf_1
    v_lshlrev_b32 v5, 2, v0
    v_add_u32 v5, s54, v5
    global_load_dword a28, v5, s[52:53]
Lcpf_1:
    v_lshrrev_b32 v4, 6, v0
    v_and_b32 v1, 63, v0
    v_readfirstlane_b32 s44, v4
    v_and_b32 v2, 15, v0
    v_bfe_u32 v3, v0, 4, 2
    s_and_b32 s45, s2, 7
    s_lshr_b32 s52, s2, 5
    s_lshl_b32 s52, s52, 3
    s_add_u32 s45, s45, s52
    s_lshr_b32 s46, s2, 3
    s_and_b32 s46, s46, 3
    s_lshr_b32 s52, s2, 3
    s_and_b32 s49, s52, 15
    s_lshr_b32 s52, s52, 4
    s_and_b32 s50, s2, 7
    s_lshl_b32 s50, s50, 1
    s_add_u32 s50, s50, s52
    s_getreg_b32 s48, hwreg(HW_REG_XCC_ID, 0, 3)
    s_lshl_b32 s48, s48, 14
    s_mov_b32 s47, 0
    s_lshl_b32 s56, s46, 2
    s_add_u32 s56, s56, s44
    s_min_u32 s57, s56, 13
    s_lshl_b32 s52, s44, 9
    s_add_u32 s52, s52, s45
    v_lshrrev_b32 v4, 3, v1
    v_lshlrev_b32 v4, 6, v4
    v_add_u32 v4, s52, v4
    v_mul_u32_u24 v4, 896, v4
    v_and_b32 v11, 7, v1
    v_lshlrev_b32 v11, 4, v11
    v_add_u32 v4, v4, v11
    s_waitcnt lgkmcnt(0)
    s_mov_b32 s8, s64
    s_and_b32 s9, s65, 0xffff
    s_mov_b32 s10, 0x1c0000
    s_mov_b32 s11, 0x20000
    buffer_load_dwordx4 v[128:131], v4, s[8:11], 0 offen offset:0
    buffer_load_dwordx4 v[132:135], v4, s[8:11], 0 offen offset:128
    buffer_load_dwordx4 v[136:139], v4, s[8:11], 0 offen offset:256
    buffer_load_dwordx4 v[140:143], v4, s[8:11], 0 offen offset:384
    buffer_load_dwordx4 v[144:147], v4, s[8:11], 0 offen offset:512
    buffer_load_dwordx4 v[148:151], v4, s[8:11], 0 offen offset:640
    buffer_load_dwordx4 v[152:155], v4, s[8:11], 0 offen offset:768
    s_mov_b32 s12, s82
    s_and_b32 s13, s83, 0xffff
    s_mov_b32 s14, 0x1c00000
    s_mov_b32 s15, 0x20000
    s_mov_b32 s16, s66
    s_and_b32 s17, s67, 0xffff
    s_mov_b32 s18, 0xe1000
    s_mov_b32 s19, 0x20000
    s_mov_b32 s20, s68
    s_and_b32 s21, s69, 0xffff
    s_mov_b32 s22, 0xe1000
    s_mov_b32 s23, 0x20000
    s_mov_b32 s24, s72
    s_and_b32 s25, s73, 0xffff
    s_mov_b32 s26, 0x188000
    s_mov_b32 s27, 0x20000
    s_mov_b32 s28, s74
    s_and_b32 s29, s75, 0xffff
    s_mov_b32 s30, 0x188000
    s_mov_b32 s31, 0x20000
    s_mov_b32 s32, s76
    s_and_b32 s33, s77, 0xffff
    s_mov_b32 s34, 0x188000
    s_mov_b32 s35, 0x20000
    s_mov_b32 s36, s78
    s_and_b32 s37, s79, 0xffff
    s_mov_b32 s38, 0x1c0000
    s_mov_b32 s39, 0x20000
    s_mov_b32 s40, s80
    s_and_b32 s41, s81, 0xffff
    s_mov_b32 s42, 0x100
    s_mov_b32 s43, 0x20000
    s_cmp_ge_u32 s2, 224
    s_cselect_b32 s26, 0, s26
    s_cselect_b32 s30, 0, s30
    s_or_b32 s52, s2, s44
    s_cmp_lg_u32 s52, 0
    s_cbranch_scc1 Lnononce_2
    s_or_b32 s52, s86, 1
    v_mov_b32 v4, s52
    v_mov_b32 v5, 0
    s_mov_b64 exec, 1
    buffer_store_dword v4, v5, s[40:43], 0 offen sc1
    s_mov_b64 exec, -1
Lnononce_2:
    s_cmp_lt_u32 s57, 7
    s_cselect_b32 s52, 2, 1
    s_cselect_b32 s53, 0, 7
    s_sub_u32 s53, s57, s53
    s_lshl_b32 s53, s53, 5
    s_add_u32 s53, s53, s52
    s_cmp_lt_u32 s57, 7
    s_cselect_b32 s58, 0x3f800000, 0xbf800000
    v_lshlrev_b32 v5, 1, v2
    v_add_u32 v5, s53, v5
    v_cvt_f32_u32 v5, v5
    v_mul_f32 v5, 0x3b124925, v5
    v_lshlrev_b32 v6, 3, v3
    v_cvt_f32_u32 v6, v6
    v_mul_f32 v6, v6, v5
    v_mul_f32 v7, 0x42000000, v5
    v_mov_b32 v96, v6
    v_fmamk_f32 v97, v5, 0x3f800000, v6
    v_fmamk_f32 v98, v5, 0x40000000, v6
    v_fmamk_f32 v99, v5, 0x40400000, v6
    v_fmamk_f32 v100, v5, 0x40800000, v6
    v_fmamk_f32 v101, v5, 0x40a00000, v6
    v_fmamk_f32 v102, v5, 0x40c00000, v6
    v_fmamk_f32 v103, v5, 0x40e00000, v6
    v_cos_f32 v8, v7
    v_sin_f32 v9, v7
    v_cos_f32 v104, v96
    v_cos_f32 v105, v97
    v_cos_f32 v106, v98
    v_cos_f32 v107, v99
    v_cos_f32 v108, v100
    v_cos_f32 v109, v101
    v_cos_f32 v110, v102
    v_cos_f32 v111, v103
    v_sin_f32_e64 v112, -v96
    v_sin_f32_e64 v113, -v97
    v_sin_f32_e64 v114, -v98
    v_sin_f32_e64 v115, -v99
    v_sin_f32_e64 v116, -v100
    v_sin_f32_e64 v117, -v101
    v_sin_f32_e64 v118, -v102
    v_sin_f32_e64 v119, -v103
    v_pk_mul_f32 v[160:161], v[104:105], v[8:9] op_sel:[0,0] op_sel_hi:[1,0]
    v_pk_mul_f32 v[168:169], v[112:113], v[8:9] op_sel:[0,0] op_sel_hi:[1,0]
    v_pk_mul_f32 v[162:163], v[106:107], v[8:9] op_sel:[0,0] op_sel_hi:[1,0]
    v_pk_mul_f32 v[170:171], v[114:115], v[8:9] op_sel:[0,0] op_sel_hi:[1,0]
    v_pk_mul_f32 v[164:165], v[108:109], v[8:9] op_sel:[0,0] op_sel_hi:[1,0]
    v_pk_mul_f32 v[172:173], v[116:117], v[8:9] op_sel:[0,0] op_sel_hi:[1,0]
    v_pk_mul_f32 v[166:167], v[110:111], v[8:9] op_sel:[0,0] op_sel_hi:[1,0]
    v_pk_mul_f32 v[174:175], v[118:119], v[8:9] op_sel:[0,0] op_sel_hi:[1,0]
    v_pk_fma_f32 v[160:161], v[112:113], v[8:9], v[160:161] op_sel:[0,1,0] op_sel_hi:[1,1,1]
    v_pk_fma_f32 v[168:169], v[104:105], v[8:9], v[168:169] op_sel:[0,1,0] op_sel_hi:[1,1,1] neg_lo:[0,1,0] neg_hi:[0,1,0]
    v_pk_fma_f32 v[162:163], v[114:115], v[8:9], v[162:163] op_sel:[0,1,0] op_sel_hi:[1,1,1]
    v_pk_fma_f32 v[170:171], v[106:107], v[8:9], v[170:171] op_sel:[0,1,0] op_sel_hi:[1,1,1] neg_lo:[0,1,0] neg_hi:[0,1,0]
    v_pk_fma_f32 v[164:165], v[116:117], v[8:9], v[164:165] op_sel:[0,1,0] op_sel_hi:[1,1,1]
    v_pk_fma_f32 v[172:173], v[108:109], v[8:9], v[172:173] op_sel:[0,1,0] op_sel_hi:[1,1,1] neg_lo:[0,1,0] neg_hi:[0,1,0]
    v_pk_fma_f32 v[166:167], v[118:119], v[8:9], v[166:167] op_sel:[0,1,0] op_sel_hi:[1,1,1]
    v_pk_fma_f32 v[174:175], v[110:111], v[8:9], v[174:175] op_sel:[0,1,0] op_sel_hi:[1,1,1] neg_lo:[0,1,0] neg_hi:[0,1,0]
    v_cvt_pk_bf16_f32 v16, v104, v105
    v_cvt_pk_bf16_f32 v17, v106, v107
    v_cvt_pk_bf16_f32 v18, v108, v109
    v_cvt_pk_bf16_f32 v19, v110, v111
    v_cvt_pk_bf16_f32 v20, v112, v113
    v_cvt_pk_bf16_f32 v21, v114, v115
    v_cvt_pk_bf16_f32 v22, v116, v117
    v_cvt_pk_bf16_f32 v23, v118, v119
    v_pk_mul_f32 v[104:105], v[160:161], v[8:9] op_sel:[0,0] op_sel_hi:[1,0]
    v_pk_mul_f32 v[112:113], v[168:169], v[8:9] op_sel:[0,0] op_sel_hi:[1,0]
    v_pk_mul_f32 v[106:107], v[162:163], v[8:9] op_sel:[0,0] op_sel_hi:[1,0]
    v_pk_mul_f32 v[114:115], v[170:171], v[8:9] op_sel:[0,0] op_sel_hi:[1,0]
    v_pk_mul_f32 v[108:109], v[164:165], v[8:9] op_sel:[0,0] op_sel_hi:[1,0]
    v_pk_mul_f32 v[116:117], v[172:173], v[8:9] op_sel:[0,0] op_sel_hi:[1,0]
    v_pk_mul_f32 v[110:111], v[166:167], v[8:9] op_sel:[0,0] op_sel_hi:[1,0]
    v_pk_mul_f32 v[118:119], v[174:175], v[8:9] op_sel:[0,0] op_sel_hi:[1,0]
    v_pk_fma_f32 v[104:105], v[168:169], v[8:9], v[104:105] op_sel:[0,1,0] op_sel_hi:[1,1,1]
    v_pk_fma_f32 v[112:113], v[160:161], v[8:9], v[112:113] op_sel:[0,1,0] op_sel_hi:[1,1,1] neg_lo:[0,1,0] neg_hi:[0,1,0]
    v_pk_fma_f32 v[106:107], v[170:171], v[8:9], v[106:107] op_sel:[0,1,0] op_sel_hi:[1,1,1]
    v_pk_fma_f32 v[114:115], v[162:163], v[8:9], v[114:115] op_sel:[0,1,0] op_sel_hi:[1,1,1] neg_lo:[0,1,0] neg_hi:[0,1,0]
    v_pk_fma_f32 v[108:109], v[172:173], v[8:9], v[108:109] op_sel:[0,1,0] op_sel_hi:[1,1,1]
    v_pk_fma_f32 v[116:117], v[164:165], v[8:9], v[116:117] op_sel:[0,1,0] op_sel_hi:[1,1,1] neg_lo:[0,1,0] neg_hi:[0,1,0]
    v_pk_fma_f32 v[110:111], v[174:175], v[8:9], v[110:111] op_sel:[0,1,0] op_sel_hi:[1,1,1]
    v_pk_fma_f32 v[118:119], v[166:167], v[8:9], v[118:119] op_sel:[0,1,0] op_sel_hi:[1,1,1] neg_lo:[0,1,0] neg_hi:[0,1,0]
    v_cvt_pk_bf16_f32 v24, v160, v161
    v_cvt_pk_bf16_f32 v25, v162, v163
    v_cvt_pk_bf16_f32 v26, v164, v165
    v_cvt_pk_bf16_f32 v27, v166, v167
    v_cvt_pk_bf16_f32 v28, v168, v169
    v_cvt_pk_bf16_f32 v29, v170, v171
    v_cvt_pk_bf16_f32 v30, v172, v173
    v_cvt_pk_bf16_f32 v31, v174, v175
    v_pk_mul_f32 v[160:161], v[104:105], v[8:9] op_sel:[0,0] op_sel_hi:[1,0]
    v_pk_mul_f32 v[168:169], v[112:113], v[8:9] op_sel:[0,0] op_sel_hi:[1,0]
    v_pk_mul_f32 v[162:163], v[106:107], v[8:9] op_sel:[0,0] op_sel_hi:[1,0]
    v_pk_mul_f32 v[170:171], v[114:115], v[8:9] op_sel:[0,0] op_sel_hi:[1,0]
    v_pk_mul_f32 v[164:165], v[108:109], v[8:9] op_sel:[0,0] op_sel_hi:[1,0]
    v_pk_mul_f32 v[172:173], v[116:117], v[8:9] op_sel:[0,0] op_sel_hi:[1,0]
    v_pk_mul_f32 v[166:167], v[110:111], v[8:9] op_sel:[0,0] op_sel_hi:[1,0]
    v_pk_mul_f32 v[174:175], v[118:119], v[8:9] op_sel:[0,0] op_sel_hi:[1,0]
    v_pk_fma_f32 v[160:161], v[112:113], v[8:9], v[160:161] op_sel:[0,1,0] op_sel_hi:[1,1,1]
    v_pk_fma_f32 v[168:169], v[104:105], v[8:9], v[168:169] op_sel:[0,1,0] op_sel_hi:[1,1,1] neg_lo:[0,1,0] neg_hi:[0,1,0]
    v_pk_fma_f32 v[162:163], v[114:115], v[8:9], v[162:163] op_sel:[0,1,0] op_sel_hi:[1,1,1]
    v_pk_fma_f32 v[170:171], v[106:107], v[8:9], v[170:171] op_sel:[0,1,0] op_sel_hi:[1,1,1] neg_lo:[0,1,0] neg_hi:[0,1,0]
    v_pk_fma_f32 v[164:165], v[116:117], v[8:9], v[164:165] op_sel:[0,1,0] op_sel_hi:[1,1,1]
    v_pk_fma_f32 v[172:173], v[108:109], v[8:9], v[172:173] op_sel:[0,1,0] op_sel_hi:[1,1,1] neg_lo:[0,1,0] neg_hi:[0,1,0]
    v_pk_fma_f32 v[166:167], v[118:119], v[8:9], v[166:167] op_sel:[0,1,0] op_sel_hi:[1,1,1]
    v_pk_fma_f32 v[174:175], v[110:111], v[8:9], v[174:175] op_sel:[0,1,0] op_sel_hi:[1,1,1] neg_lo:[0,1,0] neg_hi:[0,1,0]
    v_cvt_pk_bf16_f32 v32, v104, v105
    v_cvt_pk_bf16_f32 v33, v106, v107
    v_cvt_pk_bf16_f32 v34, v108, v109
    v_cvt_pk_bf16_f32 v35, v110, v111
    v_cvt_pk_bf16_f32 v36, v112, v113
    v_cvt_pk_bf16_f32 v37, v114, v115
    v_cvt_pk_bf16_f32 v38, v116, v117
    v_cvt_pk_bf16_f32 v39, v118, v119
    v_pk_mul_f32 v[104:105], v[160:161], v[8:9] op_sel:[0,0] op_sel_hi:[1,0]
    v_pk_mul_f32 v[112:113], v[168:169], v[8:9] op_sel:[0,0] op_sel_hi:[1,0]
    v_pk_mul_f32 v[106:107], v[162:163], v[8:9] op_sel:[0,0] op_sel_hi:[1,0]
    v_pk_mul_f32 v[114:115], v[170:171], v[8:9] op_sel:[0,0] op_sel_hi:[1,0]
    v_pk_mul_f32 v[108:109], v[164:165], v[8:9] op_sel:[0,0] op_sel_hi:[1,0]
    v_pk_mul_f32 v[116:117], v[172:173], v[8:9] op_sel:[0,0] op_sel_hi:[1,0]
    v_pk_mul_f32 v[110:111], v[166:167], v[8:9] op_sel:[0,0] op_sel_hi:[1,0]
    v_pk_mul_f32 v[118:119], v[174:175], v[8:9] op_sel:[0,0] op_sel_hi:[1,0]
    v_pk_fma_f32 v[104:105], v[168:169], v[8:9], v[104:105] op_sel:[0,1,0] op_sel_hi:[1,1,1]
    v_pk_fma_f32 v[112:113], v[160:161], v[8:9], v[112:113] op_sel:[0,1,0] op_sel_hi:[1,1,1] neg_lo:[0,1,0] neg_hi:[0,1,0]
    v_pk_fma_f32 v[106:107], v[170:171], v[8:9], v[106:107] op_sel:[0,1,0] op_sel_hi:[1,1,1]
    v_pk_fma_f32 v[114:115], v[162:163], v[8:9], v[114:115] op_sel:[0,1,0] op_sel_hi:[1,1,1] neg_lo:[0,1,0] neg_hi:[0,1,0]
    v_pk_fma_f32 v[108:109], v[172:173], v[8:9], v[108:109] op_sel:[0,1,0] op_sel_hi:[1,1,1]
    v_pk_fma_f32 v[116:117], v[164:165], v[8:9], v[116:117] op_sel:[0,1,0] op_sel_hi:[1,1,1] neg_lo:[0,1,0] neg_hi:[0,1,0]
    v_pk_fma_f32 v[110:111], v[174:175], v[8:9], v[110:111] op_sel:[0,1,0] op_sel_hi:[1,1,1]
    v_pk_fma_f32 v[118:119], v[166:167], v[8:9], v[118:119] op_sel:[0,1,0] op_sel_hi:[1,1,1] neg_lo:[0,1,0] neg_hi:[0,1,0]
    v_cvt_pk_bf16_f32 v40, v160, v161
    v_cvt_pk_bf16_f32 v41, v162, v163
    v_cvt_pk_bf16_f32 v42, v164, v165
    v_cvt_pk_bf16_f32 v43, v166, v167
    v_cvt_pk_bf16_f32 v44, v168, v169
    v_cvt_pk_bf16_f32 v45, v170, v171
    v_cvt_pk_bf16_f32 v46, v172, v173
    v_cvt_pk_bf16_f32 v47, v174, v175
    v_pk_mul_f32 v[160:161], v[104:105], v[8:9] op_sel:[0,0] op_sel_hi:[1,0]
    v_pk_mul_f32 v[168:169], v[112:113], v[8:9] op_sel:[0,0] op_sel_hi:[1,0]
    v_pk_mul_f32 v[162:163], v[106:107], v[8:9] op_sel:[0,0] op_sel_hi:[1,0]
    v_pk_mul_f32 v[170:171], v[114:115], v[8:9] op_sel:[0,0] op_sel_hi:[1,0]
    v_pk_mul_f32 v[164:165], v[108:109], v[8:9] op_sel:[0,0] op_sel_hi:[1,0]
    v_pk_mul_f32 v[172:173], v[116:117], v[8:9] op_sel:[0,0] op_sel_hi:[1,0]
    v_pk_mul_f32 v[166:167], v[110:111], v[8:9] op_sel:[0,0] op_sel_hi:[1,0]
    v_pk_mul_f32 v[174:175], v[118:119], v[8:9] op_sel:[0,0] op_sel_hi:[1,0]
    v_pk_fma_f32 v[160:161], v[112:113], v[8:9], v[160:161] op_sel:[0,1,0] op_sel_hi:[1,1,1]
    v_pk_fma_f32 v[168:169], v[104:105], v[8:9], v[168:169] op_sel:[0,1,0] op_sel_hi:[1,1,1] neg_lo:[0,1,0] neg_hi:[0,1,0]
    v_pk_fma_f32 v[162:163], v[114:115], v[8:9], v[162:163] op_sel:[0,1,0] op_sel_hi:[1,1,1]
    v_pk_fma_f32 v[170:171], v[106:107], v[8:9], v[170:171] op_sel:[0,1,0] op_sel_hi:[1,1,1] neg_lo:[0,1,0] neg_hi:[0,1,0]
    v_pk_fma_f32 v[164:165], v[116:117], v[8:9], v[164:165] op_sel:[0,1,0] op_sel_hi:[1,1,1]
    v_pk_fma_f32 v[172:173], v[108:109], v[8:9], v[172:173] op_sel:[0,1,0] op_sel_hi:[1,1,1] neg_lo:[0,1,0] neg_hi:[0,1,0]
    v_pk_fma_f32 v[166:167], v[118:119], v[8:9], v[166:167] op_sel:[0,1,0] op_sel_hi:[1,1,1]
    v_pk_fma_f32 v[174:175], v[110:111], v[8:9], v[174:175] op_sel:[0,1,0] op_sel_hi:[1,1,1] neg_lo:[0,1,0] neg_hi:[0,1,0]
    v_cvt_pk_bf16_f32 v48, v104, v105
    v_cvt_pk_bf16_f32 v49, v106, v107
    v_cvt_pk_bf16_f32 v50, v108, v109
    v_cvt_pk_bf16_f32 v51, v110, v111
    v_cvt_pk_bf16_f32 v52, v112, v113
    v_cvt_pk_bf16_f32 v53, v114, v115
    v_cvt_pk_bf16_f32 v54, v116, v117
    v_cvt_pk_bf16_f32 v55, v118, v119
    v_pk_mul_f32 v[104:105], v[160:161], v[8:9] op_sel:[0,0] op_sel_hi:[1,0]
    v_pk_mul_f32 v[112:113], v[168:169], v[8:9] op_sel:[0,0] op_sel_hi:[1,0]
    v_pk_mul_f32 v[106:107], v[162:163], v[8:9] op_sel:[0,0] op_sel_hi:[1,0]
    v_pk_mul_f32 v[114:115], v[170:171], v[8:9] op_sel:[0,0] op_sel_hi:[1,0]
    v_pk_mul_f32 v[108:109], v[164:165], v[8:9] op_sel:[0,0] op_sel_hi:[1,0]
    v_pk_mul_f32 v[116:117], v[172:173], v[8:9] op_sel:[0,0] op_sel_hi:[1,0]
    v_pk_mul_f32 v[110:111], v[166:167], v[8:9] op_sel:[0,0] op_sel_hi:[1,0]
    v_pk_mul_f32 v[118:119], v[174:175], v[8:9] op_sel:[0,0] op_sel_hi:[1,0]
    v_pk_fma_f32 v[104:105], v[168:169], v[8:9], v[104:105] op_sel:[0,1,0] op_sel_hi:[1,1,1]
    v_pk_fma_f32 v[112:113], v[160:161], v[8:9], v[112:113] op_sel:[0,1,0] op_sel_hi:[1,1,1] neg_lo:[0,1,0] neg_hi:[0,1,0]
    v_pk_fma_f32 v[106:107], v[170:171], v[8:9], v[106:107] op_sel:[0,1,0] op_sel_hi:[1,1,1]
    v_pk_fma_f32 v[114:115], v[162:163], v[8:9], v[114:115] op_sel:[0,1,0] op_sel_hi:[1,1,1] neg_lo:[0,1,0] neg_hi:[0,1,0]
    v_pk_fma_f32 v[108:109], v[172:173], v[8:9], v[108:109] op_sel:[0,1,0] op_sel_hi:[1,1,1]
    v_pk_fma_f32 v[116:117], v[164:165], v[8:9], v[116:117] op_sel:[0,1,0] op_sel_hi:[1,1,1] neg_lo:[0,1,0] neg_hi:[0,1,0]
    v_pk_fma_f32 v[110:111], v[174:175], v[8:9], v[110:111] op_sel:[0,1,0] op_sel_hi:[1,1,1]
    v_pk_fma_f32 v[118:119], v[166:167], v[8:9], v[118:119] op_sel:[0,1,0] op_sel_hi:[1,1,1] neg_lo:[0,1,0] neg_hi:[0,1,0]
    v_cvt_pk_bf16_f32 v56, v160, v161
    v_cvt_pk_bf16_f32 v57, v162, v163
    v_cvt_pk_bf16_f32 v58, v164, v165
    v_cvt_pk_bf16_f32 v59, v166, v167
    v_cvt_pk_bf16_f32 v60, v168, v169
    v_cvt_pk_bf16_f32 v61, v170, v171
    v_cvt_pk_bf16_f32 v62, v172, v173
    v_cvt_pk_bf16_f32 v63, v174, v175
    v_cvt_pk_bf16_f32 v64, v104, v105
    v_cvt_pk_bf16_f32 v65, v106, v107
    v_cvt_pk_bf16_f32 v66, v108, v109
    v_cvt_pk_bf16_f32 v67, v110, v111
    v_cvt_pk_bf16_f32 v68, v112, v113
    v_cvt_pk_bf16_f32 v69, v114, v115
    v_cvt_pk_bf16_f32 v70, v116, v117
    v_cvt_pk_bf16_f32 v71, v118, v119
    s_mov_b32 s52, 0x80008000
    v_cvt_f32_u32 v7, s45
    v_mul_f32 v7, 0x3c800000, v7
    v_lshlrev_b32 v8, 2, v3
    v_cvt_f32_u32 v8, v8
    v_add_f32 v8, v8, v7
    v_add_u32 v9, 0, v2
    v_cvt_f32_u32 v9, v9
    v_mul_f32 v9, 0x3d000000, v9
    v_mul_f32 v10, v9, v8
    v_mov_b32 v96, v10
    v_fmamk_f32 v97, v9, 0x3f800000, v10
    v_fmamk_f32 v98, v9, 0x40000000, v10
    v_fmamk_f32 v99, v9, 0x40400000, v10
    v_fmamk_f32 v100, v9, 0x41800000, v10
    v_fmamk_f32 v101, v9, 0x41880000, v10
    v_fmamk_f32 v102, v9, 0x41900000, v10
    v_fmamk_f32 v103, v9, 0x41980000, v10
    v_cos_f32 v104, v96
    v_cos_f32 v105, v97
    v_cos_f32 v106, v98
    v_cos_f32 v107, v99
    v_cos_f32 v108, v100
    v_cos_f32 v109, v101
    v_cos_f32 v110, v102
    v_cos_f32 v111, v103
    v_sin_f32 v112, v96
    v_sin_f32 v113, v97
    v_sin_f32 v114, v98
    v_sin_f32 v115, v99
    v_sin_f32 v116, v100
    v_sin_f32 v117, v101
    v_sin_f32 v118, v102
    v_sin_f32 v119, v103
    v_cvt_pk_bf16_f32 v72, v104, v105
    v_cvt_pk_bf16_f32 v73, v106, v107
    v_cvt_pk_bf16_f32 v74, v108, v109
    v_cvt_pk_bf16_f32 v75, v110, v111
    v_cvt_pk_bf16_f32 v76, v112, v113
    v_cvt_pk_bf16_f32 v77, v114, v115
    v_cvt_pk_bf16_f32 v78, v116, v117
    v_cvt_pk_bf16_f32 v79, v118, v119
    v_xor_b32 v80, s52, v76
    v_xor_b32 v81, s52, v77
    v_xor_b32 v82, s52, v78
    v_xor_b32 v83, s52, v79
    v_add_u32 v9, 16, v2
    v_cvt_f32_u32 v9, v9
    v_mul_f32 v9, 0x3d000000, v9
    v_mul_f32 v10, v9, v8
    v_mov_b32 v96, v10
    v_fmamk_f32 v97, v9, 0x3f800000, v10
    v_fmamk_f32 v98, v9, 0x40000000, v10
    v_fmamk_f32 v99, v9, 0x40400000, v10
    v_fmamk_f32 v100, v9, 0x41800000, v10
    v_fmamk_f32 v101, v9, 0x41880000, v10
    v_fmamk_f32 v102, v9, 0x41900000, v10
    v_fmamk_f32 v103, v9, 0x41980000, v10
    v_cos_f32 v104, v96
    v_cos_f32 v105, v97
    v_cos_f32 v106, v98
    v_cos_f32 v107, v99
    v_cos_f32 v108, v100
    v_cos_f32 v109, v101
    v_cos_f32 v110, v102
    v_cos_f32 v111, v103
    v_sin_f32 v112, v96
    v_sin_f32 v113, v97
    v_sin_f32 v114, v98
    v_sin_f32 v115, v99
    v_sin_f32 v116, v100
    v_sin_f32 v117, v101
    v_sin_f32 v118, v102
    v_sin_f32 v119, v103
    v_cvt_pk_bf16_f32 v84, v104, v105
    v_cvt_pk_bf16_f32 v85, v106, v107
    v_cvt_pk_bf16_f32 v86, v108, v109
    v_cvt_pk_bf16_f32 v87, v110, v111
    v_cvt_pk_bf16_f32 v88, v112, v113
    v_cvt_pk_bf16_f32 v89, v114, v115
    v_cvt_pk_bf16_f32 v90, v116, v117
    v_cvt_pk_bf16_f32 v91, v118, v119
    v_xor_b32 v92, s52, v88
    v_xor_b32 v93, s52, v89
    v_xor_b32 v94, s52, v90
    v_xor_b32 v95, s52, v91
    s_lshl_b32 s52, s2, 12
    v_lshlrev_b32 v12, 4, v0
    v_add_u32 v12, s52, v12
    buffer_load_dwordx4 a[32:35], v12, s[16:19], 0 offen
    buffer_load_dwordx4 a[32:35], v12, s[20:23], 0 offen
    s_lshr_b32 s52, s2, 4
    s_lshl_b32 s52, s52, 4
    s_mul_i32 s52, s52, 3584
    s_and_b32 s54, s2, 15
    s_mul_i32 s54, s54, 224
    s_add_u32 s52, s52, s54
    s_mov_b32 s94, s26
    s_mov_b32 s95, 0x20000
    s_lshl_b32 s53, s44, 2
    s_add_u32 s53, s53, 0
    s_cmp_ge_u32 s53, 7
    s_cselect_b32 s54, 7, 0
    s_cselect_b32 s55, 9344, 0
    s_sub_u32 s54, s53, s54
    s_lshl_b32 s54, s54, 6
    s_add_u32 s55, s55, 32768
    v_add_u32 v12, s54, v1
    v_mul_u32_u24 v13, 4682, v12
    v_lshrrev_b32 v13, 16, v13
    v_mul_u32_u24 v14, 14, v13
    v_sub_u32 v14, v12, v14
    v_lshlrev_b32 v14, 4, v14
    v_mul_u32_u24 v15, 288, v13
    v_add3_u32 v252, v15, v14, s55
    v_lshrrev_b32 v15, 4, v13
    v_mul_u32_u24 v15, 208, v15
    v_add_u32 v15, v15, v13
    v_mul_u32_u24 v15, 3584, v15
    v_add_u32 v15, v15, v14
    s_cmp_ge_u32 s53, 7
    s_cselect_b32 s92, s28, s24
    s_cselect_b32 s93, s29, s25
    buffer_load_dwordx4 a[0:3], v15, s[92:95], s52 offen
    s_lshl_b32 s53, s44, 2
    s_add_u32 s53, s53, 1
    s_cmp_ge_u32 s53, 7
    s_cselect_b32 s54, 7, 0
    s_cselect_b32 s55, 9344, 0
    s_sub_u32 s54, s53, s54
    s_lshl_b32 s54, s54, 6
    s_add_u32 s55, s55, 32768
    v_add_u32 v12, s54, v1
    v_mul_u32_u24 v13, 4682, v12
    v_lshrrev_b32 v13, 16, v13
    v_mul_u32_u24 v14, 14, v13
    v_sub_u32 v14, v12, v14
    v_lshlrev_b32 v14, 4, v14
    v_mul_u32_u24 v15, 288, v13
    v_add3_u32 v253, v15, v14, s55
    v_lshrrev_b32 v15, 4, v13
    v_mul_u32_u24 v15, 208, v15
    v_add_u32 v15, v15, v13
    v_mul_u32_u24 v15, 3584, v15
    v_add_u32 v15, v15, v14
    s_cmp_ge_u32 s53, 7
    s_cselect_b32 s92, s28, s24
    s_cselect_b32 s93, s29, s25
    buffer_load_dwordx4 a[4:7], v15, s[92:95], s52 offen
    s_lshl_b32 s53, s44, 2
    s_add_u32 s53, s53, 2
    s_cmp_ge_u32 s53, 7
    s_cselect_b32 s54, 7, 0
    s_cselect_b32 s55, 9344, 0
    s_sub_u32 s54, s53, s54
    s_lshl_b32 s54, s54, 6
    s_add_u32 s55, s55, 32768
    v_add_u32 v12, s54, v1
    v_mul_u32_u24 v13, 4682, v12
    v_lshrrev_b32 v13, 16, v13
    v_mul_u32_u24 v14, 14, v13
    v_sub_u32 v14, v12, v14
    v_lshlrev_b32 v14, 4, v14
    v_mul_u32_u24 v15, 288, v13
    v_add3_u32 v254, v15, v14, s55
    v_lshrrev_b32 v15, 4, v13
    v_mul_u32_u24 v15, 208, v15
    v_add_u32 v15, v15, v13
    v_mul_u32_u24 v15, 3584, v15
    v_add_u32 v15, v15, v14
    s_cmp_ge_u32 s53, 7
    s_cselect_b32 s92, s28, s24
    s_cselect_b32 s93, s29, s25
    s_cmp_ge_u32 s53, 14
    s_cselect_b32 s94, 0, s94
    buffer_load_dwordx4 a[8:11], v15, s[92:95], s52 offen
    s_lshl_b32 s53, s44, 2
    s_add_u32 s53, s53, 3
    s_cmp_ge_u32 s53, 7
    s_cselect_b32 s54, 7, 0
    s_cselect_b32 s55, 9344, 0
    s_sub_u32 s54, s53, s54
    s_lshl_b32 s54, s54, 6
    s_add_u32 s55, s55, 32768
    v_add_u32 v12, s54, v1
    v_mul_u32_u24 v13, 4682, v12
    v_lshrrev_b32 v13, 16, v13
    v_mul_u32_u24 v14, 14, v13
    v_sub_u32 v14, v12, v14
    v_lshlrev_b32 v14, 4, v14
    v_mul_u32_u24 v15, 288, v13
    v_add3_u32 v10, v15, v14, s55
    v_accvgpr_write_b32 a25, v10
    v_lshrrev_b32 v15, 4, v13
    v_mul_u32_u24 v15, 208, v15
    v_add_u32 v15, v15, v13
    v_mul_u32_u24 v15, 3584, v15
    v_add_u32 v15, v15, v14
    s_cmp_ge_u32 s53, 7
    s_cselect_b32 s92, s28, s24
    s_cselect_b32 s93, s29, s25
    s_cmp_ge_u32 s53, 14
    s_cselect_b32 s94, 0, s94
    buffer_load_dwordx4 a[12:15], v15, s[92:95], s52 offen
    v_lshrrev_b32 v5, 3, v1
    s_and_b32 s52, s44, 1
    s_lshl_b32 s52, s52, 3
    v_add_u32 v5, s52, v5
    v_and_b32 v6, 7, v1
    v_xor_b32 v7, v5, v6
    v_lshlrev_b32 v7, 4, v7
    v_and_b32 v8, 3, v6
    v_lshlrev_b32 v8, 8, v8
    v_add_u32 v7, v7, v8
    v_lshrrev_b32 v8, 2, v6
    v_lshlrev_b32 v8, 10, v8
    v_add_u32 v7, v7, v8
    s_lshr_b32 s52, s44, 1
    s_mul_i32 s52, s52, 14336
    v_add_u32 v4, s52, v7
    v_mov_b32 v5, 0
    v_mov_b32 v6, 0
    s_mov_b32 s52, 0x3f803f80
    s_waitcnt vmcnt(12)
    ds_write_b128 v4, v[128:131] offset:0
    v_dot2_f32_bf16 v5, v128, s52, v5
    v_dot2_f32_bf16 v6, v128, v128, v6
    v_dot2_f32_bf16 v5, v129, s52, v5
    v_dot2_f32_bf16 v6, v129, v129, v6
    v_dot2_f32_bf16 v5, v130, s52, v5
    v_dot2_f32_bf16 v6, v130, v130, v6
    v_dot2_f32_bf16 v5, v131, s52, v5
    v_dot2_f32_bf16 v6, v131, v131, v6
    s_waitcnt vmcnt(11)
    ds_write_b128 v4, v[132:135] offset:2048
    v_dot2_f32_bf16 v5, v132, s52, v5
    v_dot2_f32_bf16 v6, v132, v132, v6
    v_dot2_f32_bf16 v5, v133, s52, v5
    v_dot2_f32_bf16 v6, v133, v133, v6
    v_dot2_f32_bf16 v5, v134, s52, v5
    v_dot2_f32_bf16 v6, v134, v134, v6
    v_dot2_f32_bf16 v5, v135, s52, v5
    v_dot2_f32_bf16 v6, v135, v135, v6
    s_waitcnt vmcnt(10)
    ds_write_b128 v4, v[136:139] offset:4096
    v_dot2_f32_bf16 v5, v136, s52, v5
    v_dot2_f32_bf16 v6, v136, v136, v6
    v_dot2_f32_bf16 v5, v137, s52, v5
    v_dot2_f32_bf16 v6, v137, v137, v6
    v_dot2_f32_bf16 v5, v138, s52, v5
    v_dot2_f32_bf16 v6, v138, v138, v6
    v_dot2_f32_bf16 v5, v139, s52, v5
    v_dot2_f32_bf16 v6, v139, v139, v6
    s_waitcnt vmcnt(9)
    ds_write_b128 v4, v[140:143] offset:6144
    v_dot2_f32_bf16 v5, v140, s52, v5
    v_dot2_f32_bf16 v6, v140, v140, v6
    v_dot2_f32_bf16 v5, v141, s52, v5
    v_dot2_f32_bf16 v6, v141, v141, v6
    v_dot2_f32_bf16 v5, v142, s52, v5
    v_dot2_f32_bf16 v6, v142, v142, v6
    v_dot2_f32_bf16 v5, v143, s52, v5
    v_dot2_f32_bf16 v6, v143, v143, v6
    s_waitcnt vmcnt(8)
    ds_write_b128 v4, v[144:147] offset:8192
    v_dot2_f32_bf16 v5, v144, s52, v5
    v_dot2_f32_bf16 v6, v144, v144, v6
    v_dot2_f32_bf16 v5, v145, s52, v5
    v_dot2_f32_bf16 v6, v145, v145, v6
    v_dot2_f32_bf16 v5, v146, s52, v5
    v_dot2_f32_bf16 v6, v146, v146, v6
    v_dot2_f32_bf16 v5, v147, s52, v5
    v_dot2_f32_bf16 v6, v147, v147, v6
    s_waitcnt vmcnt(7)
    ds_write_b128 v4, v[148:151] offset:10240
    v_dot2_f32_bf16 v5, v148, s52, v5
    v_dot2_f32_bf16 v6, v148, v148, v6
    v_dot2_f32_bf16 v5, v149, s52, v5
    v_dot2_f32_bf16 v6, v149, v149, v6
    v_dot2_f32_bf16 v5, v150, s52, v5
    v_dot2_f32_bf16 v6, v150, v150, v6
    v_dot2_f32_bf16 v5, v151, s52, v5
    v_dot2_f32_bf16 v6, v151, v151, v6
    s_waitcnt vmcnt(6)
    ds_write_b128 v4, v[152:155] offset:12288
    v_dot2_f32_bf16 v5, v152, s52, v5
    v_dot2_f32_bf16 v6, v152, v152, v6
    v_dot2_f32_bf16 v5, v153, s52, v5
    v_dot2_f32_bf16 v6, v153, v153, v6
    v_dot2_f32_bf16 v5, v154, s52, v5
    v_dot2_f32_bf16 v6, v154, v154, v6
    v_dot2_f32_bf16 v5, v155, s52, v5
    v_dot2_f32_bf16 v6, v155, v155, v6
    s_nop 1
    v_add_f32_dpp v5, v5, v5 quad_perm:[1,0,3,2] row_mask:0xf bank_mask:0xf
    v_add_f32_dpp v6, v6, v6 quad_perm:[1,0,3,2] row_mask:0xf bank_mask:0xf
    s_nop 0
    v_add_f32_dpp v5, v5, v5 quad_perm:[2,3,0,1] row_mask:0xf bank_mask:0xf
    v_add_f32_dpp v6, v6, v6 quad_perm:[2,3,0,1] row_mask:0xf bank_mask:0xf
    s_nop 0
    v_add_f32_dpp v5, v5, v5 row_half_mirror row_mask:0xf bank_mask:0xf
    v_add_f32_dpp v6, v6, v6 row_half_mirror row_mask:0xf bank_mask:0xf
    v_mul_f32 v5, 0x3b124925, v5
    v_mul_f32 v6, 0x3b124925, v6
    v_fma_f32 v6, -v5, v5, v6
    v_max_f32 v6, 0, v6
    v_add_f32 v6, 0x3727c5ac, v6
    v_rsq_f32 v6, v6
    v_lshrrev_b32 v7, 3, v1
    s_lshl_b32 s52, s44, 3
    v_add_u32 v7, s52, v7
    v_lshlrev_b32 v7, 2, v7
    ds_write_b32 v7, v6 offset:28672
    s_cmp_lg_u32 s46, 0
    s_cbranch_scc1 Lnomean_3
    s_lshl_b32 s52, s45, 7
    s_add_u32 s52, s52, 0x800000
    buffer_store_dword v5, v7, s[12:15], s52 offen sc1
Lnomean_3:
    s_waitcnt lgkmcnt(0)
    s_barrier
    v_mov_b32 v250, 0
    buffer_load_dword v251, v250, s[40:43], 0 offen sc1
    v_xor_b32 v5, v2, v3
    v_lshlrev_b32 v6, 8, v3
    v_lshlrev_b32 v11, 4, v5
    v_add_u32 v11, v11, v6
    v_xor_b32 v5, 4, v5
    v_lshlrev_b32 v10, 4, v5
    v_add_u32 v10, v10, v6
    ds_read_b128 v[128:131], v11 offset:0
    ds_read_b128 v[184:187], v11 offset:14336
    ds_read_b128 v[132:135], v10 offset:1024
    ds_read_b128 v[188:191], v10 offset:15360
    ds_read_b128 v[136:139], v11 offset:2048
    ds_read_b128 v[192:195], v11 offset:16384
    ds_read_b128 v[140:143], v10 offset:3072
    ds_read_b128 v[196:199], v10 offset:17408
    v_lshlrev_b32 v9, 4, v3
    ds_read_b128 v[240:243], v9 offset:28672
    ds_read_b128 v[244:247], v9 offset:28736
    ds_read_b128 v[144:147], v11 offset:4096
    s_waitcnt lgkmcnt(10)
    v_mfma_f32_16x16x32_bf16 v[96:99], v[128:131], v[16:19], 0
    v_mfma_f32_16x16x32_bf16 v[104:107], v[128:131], v[20:23], 0
    ds_read_b128 v[200:203], v11 offset:18432
    s_waitcnt lgkmcnt(10)
    v_mfma_f32_16x16x32_bf16 v[112:115], v[184:187], v[16:19], 0
    v_mfma_f32_16x16x32_bf16 v[120:123], v[184:187], v[20:23], 0
    ds_read_b128 v[148:151], v10 offset:5120
    s_waitcnt lgkmcnt(10)
    v_mfma_f32_16x16x32_bf16 v[96:99], v[132:135], v[24:27], v[96:99]
    v_mfma_f32_16x16x32_bf16 v[104:107], v[132:135], v[28:31], v[104:107]
    ds_read_b128 v[204:207], v10 offset:19456
    s_waitcnt lgkmcnt(10)
    v_mfma_f32_16x16x32_bf16 v[112:115], v[188:191], v[24:27], v[112:115]
    v_mfma_f32_16x16x32_bf16 v[120:123], v[188:191], v[28:31], v[120:123]
    ds_read_b128 v[152:155], v11 offset:6144
    s_waitcnt lgkmcnt(10)
    v_mfma_f32_16x16x32_bf16 v[96:99], v[136:139], v[32:35], v[96:99]
    v_mfma_f32_16x16x32_bf16 v[104:107], v[136:139], v[36:39], v[104:107]
    ds_read_b128 v[208:211], v11 offset:20480
    s_waitcnt lgkmcnt(10)
    v_mfma_f32_16x16x32_bf16 v[112:115], v[192:195], v[32:35], v[112:115]
    v_mfma_f32_16x16x32_bf16 v[120:123], v[192:195], v[36:39], v[120:123]
    ds_read_b128 v[156:159], v10 offset:7168
    s_waitcnt lgkmcnt(10)
    v_mfma_f32_16x16x32_bf16 v[96:99], v[140:143], v[40:43], v[96:99]
    v_mfma_f32_16x16x32_bf16 v[104:107], v[140:143], v[44:47], v[104:107]
    ds_read_b128 v[212:215], v10 offset:21504
    s_waitcnt lgkmcnt(10)
    v_mfma_f32_16x16x32_bf16 v[112:115], v[196:199], v[40:43], v[112:115]
    v_mfma_f32_16x16x32_bf16 v[120:123], v[196:199], v[44:47], v[120:123]
    ds_read_b128 v[160:163], v11 offset:8192
    s_waitcnt lgkmcnt(8)
    v_mfma_f32_16x16x32_bf16 v[96:99], v[144:147], v[48:51], v[96:99]
    v_mfma_f32_16x16x32_bf16 v[104:107], v[144:147], v[52:55], v[104:107]
    ds_read_b128 v[216:219], v11 offset:22528
    s_waitcnt lgkmcnt(8)
    v_mfma_f32_16x16x32_bf16 v[112:115], v[200:203], v[48:51], v[112:115]
    v_mfma_f32_16x16x32_bf16 v[120:123], v[200:203], v[52:55], v[120:123]
    ds_read_b128 v[164:167], v10 offset:9216
    s_waitcnt lgkmcnt(8)
    v_mfma_f32_16x16x32_bf16 v[96:99], v[148:151], v[56:59], v[96:99]
    v_mfma_f32_16x16x32_bf16 v[104:107], v[148:151], v[60:63], v[104:107]
    ds_read_b128 v[220:223], v10 offset:23552
    s_waitcnt lgkmcnt(8)
    v_mfma_f32_16x16x32_bf16 v[112:115], v[204:207], v[56:59], v[112:115]
    v_mfma_f32_16x16x32_bf16 v[120:123], v[204:207], v[60:63], v[120:123]
    ds_read_b128 v[168:171], v11 offset:10240
    s_waitcnt lgkmcnt(8)
    v_mfma_f32_16x16x32_bf16 v[96:99], v[152:155], v[64:67], v[96:99]
    v_mfma_f32_16x16x32_bf16 v[104:107], v[152:155], v[68:71], v[104:107]
    ds_read_b128 v[224:227], v11 offset:24576
    s_waitcnt lgkmcnt(8)
    v_mfma_f32_16x16x32_bf16 v[112:115], v[208:211], v[64:67], v[112:115]
    v_mfma_f32_16x16x32_bf16 v[120:123], v[208:211], v[68:71], v[120:123]
    ds_read_b128 v[172:175], v10 offset:11264
    s_waitcnt lgkmcnt(8)
    v_mfma_f32_16x16x32_bf16 v[100:103], v[156:159], v[16:19], 0
    v_mfma_f32_16x16x32_bf16 v[108:111], v[156:159], v[20:23], 0
    ds_read_b128 v[228:231], v10 offset:25600
    s_waitcnt lgkmcnt(8)
    v_mfma_f32_16x16x32_bf16 v[116:119], v[212:215], v[16:19], 0
    v_mfma_f32_16x16x32_bf16 v[124:127], v[212:215], v[20:23], 0
    ds_read_b128 v[176:179], v11 offset:12288
    s_waitcnt lgkmcnt(8)
    v_mfma_f32_16x16x32_bf16 v[100:103], v[160:163], v[24:27], v[100:103]
    v_mfma_f32_16x16x32_bf16 v[108:111], v[160:163], v[28:31], v[108:111]
    ds_read_b128 v[232:235], v11 offset:26624
    s_waitcnt lgkmcnt(8)
    v_mfma_f32_16x16x32_bf16 v[116:119], v[216:219], v[24:27], v[116:119]
    v_mfma_f32_16x16x32_bf16 v[124:127], v[216:219], v[28:31], v[124:127]
    ds_read_b128 v[180:183], v10 offset:13312
    s_waitcnt lgkmcnt(8)
    v_mfma_f32_16x16x32_bf16 v[100:103], v[164:167], v[32:35], v[100:103]
    v_mfma_f32_16x16x32_bf16 v[108:111], v[164:167], v[36:39], v[108:111]
    ds_read_b128 v[236:239], v10 offset:27648
    s_waitcnt lgkmcnt(8)
    v_mfma_f32_16x16x32_bf16 v[116:119], v[220:223], v[32:35], v[116:119]
    v_mfma_f32_16x16x32_bf16 v[124:127], v[220:223], v[36:39], v[124:127]
    s_waitcnt lgkmcnt(7)
    v_mfma_f32_16x16x32_bf16 v[100:103], v[168:171], v[40:43], v[100:103]
    v_mfma_f32_16x16x32_bf16 v[108:111], v[168:171], v[44:47], v[108:111]
    s_waitcnt lgkmcnt(6)
    v_mfma_f32_16x16x32_bf16 v[116:119], v[224:227], v[40:43], v[116:119]
    v_mfma_f32_16x16x32_bf16 v[124:127], v[224:227], v[44:47], v[124:127]
    s_waitcnt lgkmcnt(5)
    v_mfma_f32_16x16x32_bf16 v[100:103], v[172:175], v[48:51], v[100:103]
    v_mfma_f32_16x16x32_bf16 v[108:111], v[172:175], v[52:55], v[108:111]
    s_waitcnt lgkmcnt(4)
    v_mfma_f32_16x16x32_bf16 v[116:119], v[228:231], v[48:51], v[116:119]
    v_mfma_f32_16x16x32_bf16 v[124:127], v[228:231], v[52:55], v[124:127]
    s_waitcnt lgkmcnt(3)
    v_mfma_f32_16x16x32_bf16 v[100:103], v[176:179], v[56:59], v[100:103]
    v_mfma_f32_16x16x32_bf16 v[108:111], v[176:179], v[60:63], v[108:111]
    s_waitcnt lgkmcnt(2)
    v_mfma_f32_16x16x32_bf16 v[116:119], v[232:235], v[56:59], v[116:119]
    v_mfma_f32_16x16x32_bf16 v[124:127], v[232:235], v[60:63], v[124:127]
    s_waitcnt lgkmcnt(1)
    v_mfma_f32_16x16x32_bf16 v[100:103], v[180:183], v[64:67], v[100:103]
    v_mfma_f32_16x16x32_bf16 v[108:111], v[180:183], v[68:71], v[108:111]
    s_waitcnt lgkmcnt(0)
    v_mfma_f32_16x16x32_bf16 v[116:119], v[236:239], v[64:67], v[116:119]
    v_mfma_f32_16x16x32_bf16 v[124:127], v[236:239], v[68:71], v[124:127]
    s_nop 3
    v_fma_f32 v136, v100, s58, v96
    v_fma_f32 v137, v101, s58, v97
    v_fma_f32 v138, v102, s58, v98
    v_fma_f32 v139, v103, s58, v99
    v_mul_f32 v136, v136, v240
    v_mul_f32 v137, v137, v241
    v_mul_f32 v138, v138, v242
    v_mul_f32 v139, v139, v243
    v_fma_f32 v140, v116, s58, v112
    v_fma_f32 v141, v117, s58, v113
    v_fma_f32 v142, v118, s58, v114
    v_fma_f32 v143, v119, s58, v115
    v_mul_f32 v140, v140, v244
    v_mul_f32 v141, v141, v245
    v_mul_f32 v142, v142, v246
    v_mul_f32 v143, v143, v247
    v_cvt_pk_bf16_f32 v128, v136, v137
    v_cvt_pk_bf16_f32 v129, v138, v139
    v_cvt_pk_bf16_f32 v130, v140, v141
    v_cvt_pk_bf16_f32 v131, v142, v143
    v_fma_f32 v136, v108, s58, v104
    v_fma_f32 v137, v109, s58, v105
    v_fma_f32 v138, v110, s58, v106
    v_fma_f32 v139, v111, s58, v107
    v_mul_f32 v136, v136, v240
    v_mul_f32 v137, v137, v241
    v_mul_f32 v138, v138, v242
    v_mul_f32 v139, v139, v243
    v_fma_f32 v140, v124, s58, v120
    v_fma_f32 v141, v125, s58, v121
    v_fma_f32 v142, v126, s58, v122
    v_fma_f32 v143, v127, s58, v123
    v_mul_f32 v140, v140, v244
    v_mul_f32 v141, v141, v245
    v_mul_f32 v142, v142, v246
    v_mul_f32 v143, v143, v247
    v_cvt_pk_bf16_f32 v132, v136, v137
    v_cvt_pk_bf16_f32 v133, v138, v139
    v_cvt_pk_bf16_f32 v134, v140, v141
    v_cvt_pk_bf16_f32 v135, v142, v143
    v_mfma_f32_16x16x32_bf16 v[144:147], v[72:75], v[128:131], 0
    v_mfma_f32_16x16x32_bf16 v[148:151], v[80:83], v[128:131], 0
    v_mfma_f32_16x16x32_bf16 v[144:147], v[76:79], v[132:135], v[144:147]
    v_mfma_f32_16x16x32_bf16 v[148:151], v[72:75], v[132:135], v[148:151]
    v_mfma_f32_16x16x32_bf16 v[152:155], v[84:87], v[128:131], 0
    v_mfma_f32_16x16x32_bf16 v[156:159], v[92:95], v[128:131], 0
    v_mfma_f32_16x16x32_bf16 v[152:155], v[88:91], v[132:135], v[152:155]
    v_mfma_f32_16x16x32_bf16 v[156:159], v[84:87], v[132:135], v[156:159]
    s_mov_b32 s52, 229376
    v_mul_lo_u32 v4, v3, s52
    v_lshlrev_b32 v5, 2, v2
    v_add_u32 v4, v4, v5
    s_lshl_b32 s52, s56, 12
    s_lshl_b32 s53, s45, 6
    s_add_u32 s52, s52, s53
    v_cvt_pk_bf16_f32 v168, v144, v148
    v_cvt_pk_bf16_f32 v169, v145, v149
    v_cvt_pk_bf16_f32 v170, v146, v150
    v_cvt_pk_bf16_f32 v171, v147, v151
    v_cvt_pk_bf16_f32 v172, v152, v156
    v_cvt_pk_bf16_f32 v173, v153, v157
    v_cvt_pk_bf16_f32 v174, v154, v158
    v_cvt_pk_bf16_f32 v175, v155, v159
    s_cmp_ge_u32 s56, 14
    s_cbranch_scc1 LnostoreA_4
    s_add_u32 s53, s52, 0
    buffer_store_dword v168, v4, s[12:15], s53 offen sc1
    s_add_u32 s53, s52, 57344
    buffer_store_dword v169, v4, s[12:15], s53 offen sc1
    s_add_u32 s53, s52, 114688
    buffer_store_dword v170, v4, s[12:15], s53 offen sc1
    s_add_u32 s53, s52, 172032
    buffer_store_dword v171, v4, s[12:15], s53 offen sc1
    s_add_u32 s53, s52, 917504
    buffer_store_dword v172, v4, s[12:15], s53 offen sc1
    s_add_u32 s53, s52, 974848
    buffer_store_dword v173, v4, s[12:15], s53 offen sc1
    s_add_u32 s53, s52, 1032192
    buffer_store_dword v174, v4, s[12:15], s53 offen sc1
    s_add_u32 s53, s52, 1089536
    buffer_store_dword v175, v4, s[12:15], s53 offen sc1
LnostoreA_4:
    s_waitcnt vmcnt(0)
    s_cmp_lg_u32 s44, 0
    s_cbranch_scc1 Lnsk_5
    s_mov_b32 s51, 0
Lnlp_6:
    v_readfirstlane_b32 s47, v251
    s_nop 1
    s_cmp_lg_u32 s47, 0
    s_cbranch_scc1 Lndn_7
    buffer_load_dword v251, v250, s[40:43], 0 offen sc1
    s_waitcnt vmcnt(0)
    s_add_u32 s51, s51, 1
    s_cmp_lt_u32 s51, 100000
    s_cbranch_scc1 Lnlp_6
Lndn_7:
Lnsk_5:
    s_cmp_lg_u32 s44, 0
    s_cbranch_scc1 Lnb_8
    v_mov_b32 v14, s47
    v_mov_b32 v15, 29696
    ds_write_b32 v15, v14
    s_waitcnt lgkmcnt(0)
Lnb_8:
    s_barrier
    s_cmp_lg_u32 s44, 0
    s_cbranch_scc1 Lsig_9
    s_lshl_b32 s52, s2, 6
    s_add_u32 s52, s52, 0x1800000
    v_mov_b32 v14, s47
    v_lshlrev_b32 v15, 14, v1
    s_mov_b64 exec, 0xff
    buffer_store_dword v14, v15, s[12:15], s52 offen sc1
    s_mov_b64 exec, -1
Lsig_9:
    v_mov_b32 v15, 29696
    ds_read_b32 v14, v15
    s_waitcnt lgkmcnt(0)
    v_readfirstlane_b32 s47, v14
    s_cmp_ge_u32 s2, 224
    s_cbranch_scc1 Lp2_10
    s_and_b32 s56, s2, 7
    s_lshr_b32 s57, s2, 3
    s_mul_i32 s52, s57, 37
    s_lshr_b32 s52, s52, 8
    s_mul_i32 s53, s52, 7
    s_sub_u32 s53, s57, s53
    s_lshl_b32 s52, s52, 3
    s_add_u32 s56, s56, s52
    s_lshl_b32 s53, s53, 1
    s_lshr_b32 s54, s44, 1
    s_add_u32 s57, s53, s54
    s_lshr_b32 s59, s53, 2
    s_and_b32 s58, s44, 1
    s_cmp_lt_u32 s57, 7
    s_cselect_b32 s52, 2, 1
    s_cselect_b32 s53, 0, 7
    s_sub_u32 s53, s57, s53
    s_lshl_b32 s53, s53, 5
    s_add_u32 s53, s53, s52
    v_lshlrev_b32 v6, 1, v2
    v_add_u32 v6, s53, v6
    v_lshlrev_b32 v6, 1, v6
    v_lshlrev_b32 v7, 7, v3
    s_lshl_b32 s52, s58, 10
    s_add_u32 s52, s52, s56
    v_add_u32 v7, s52, v7
    v_mul_u32_u24 v7, 450, v7
    v_add_u32 v6, v6, v7
    s_mov_b32 s52, 0
    buffer_load_short_d16_hi v96, v6, s[16:19], s52 offen
    buffer_load_short_d16_hi v104, v6, s[20:23], s52 offen
    s_mov_b32 s52, 14400
    buffer_load_short_d16_hi v97, v6, s[16:19], s52 offen
    buffer_load_short_d16_hi v105, v6, s[20:23], s52 offen
    s_mov_b32 s52, 28800
    buffer_load_short_d16_hi v98, v6, s[16:19], s52 offen
    buffer_load_short_d16_hi v106, v6, s[20:23], s52 offen
    s_mov_b32 s52, 43200
    buffer_load_short_d16_hi v99, v6, s[16:19], s52 offen
    buffer_load_short_d16_hi v107, v6, s[20:23], s52 offen
    s_mov_b32 s52, 230400
    buffer_load_short_d16_hi v100, v6, s[16:19], s52 offen
    buffer_load_short_d16_hi v108, v6, s[20:23], s52 offen
    s_mov_b32 s52, 244800
    buffer_load_short_d16_hi v101, v6, s[16:19], s52 offen
    buffer_load_short_d16_hi v109, v6, s[20:23], s52 offen
    s_mov_b32 s52, 259200
    buffer_load_short_d16_hi v102, v6, s[16:19], s52 offen
    buffer_load_short_d16_hi v110, v6, s[20:23], s52 offen
    s_mov_b32 s52, 273600
    buffer_load_short_d16_hi v103, v6, s[16:19], s52 offen
    buffer_load_short_d16_hi v111, v6, s[20:23], s52 offen
    s_lshl_b32 s52, s58, 5
    v_add_u32 v8, s52, v2
    v_cvt_f32_u32 v8, v8
    v_mul_f32 v8, 0x3c800000, v8
    v_lshlrev_b32 v9, 2, v3
    s_xor_b32 s52, s58, 0
    s_lshl_b32 s52, s52, 5
    v_add_u32 v10, s52, v9
    v_cvt_f32_u32 v10, v10
    v_mul_f32 v10, v10, v8
    v_mov_b32 v192, v10
    v_fmamk_f32 v193, v8, 0x3f800000, v10
    v_fmamk_f32 v194, v8, 0x40000000, v10
    v_fmamk_f32 v195, v8, 0x40400000, v10
    v_fmamk_f32 v196, v8, 0x41800000, v10
    v_fmamk_f32 v197, v8, 0x41880000, v10
    v_fmamk_f32 v198, v8, 0x41900000, v10
    v_fmamk_f32 v199, v8, 0x41980000, v10
    v_cos_f32 v160, v192
    v_cos_f32 v161, v193
    v_cos_f32 v162, v194
    v_cos_f32 v163, v195
    v_cos_f32 v164, v196
    v_cos_f32 v165, v197
    v_cos_f32 v166, v198
    v_cos_f32 v167, v199
    v_sin_f32 v176, v192
    v_sin_f32 v177, v193
    v_sin_f32 v178, v194
    v_sin_f32 v179, v195
    v_sin_f32 v180, v196
    v_sin_f32 v181, v197
    v_sin_f32 v182, v198
    v_sin_f32 v183, v199
    s_xor_b32 s52, s58, 1
    s_lshl_b32 s52, s52, 5
    v_add_u32 v10, s52, v9
    v_cvt_f32_u32 v10, v10
    v_mul_f32 v10, v10, v8
    v_mov_b32 v192, v10
    v_fmamk_f32 v193, v8, 0x3f800000, v10
    v_fmamk_f32 v194, v8, 0x40000000, v10
    v_fmamk_f32 v195, v8, 0x40400000, v10
    v_fmamk_f32 v196, v8, 0x41800000, v10
    v_fmamk_f32 v197, v8, 0x41880000, v10
    v_fmamk_f32 v198, v8, 0x41900000, v10
    v_fmamk_f32 v199, v8, 0x41980000, v10
    v_cos_f32 v168, v192
    v_cos_f32 v169, v193
    v_cos_f32 v170, v194
    v_cos_f32 v171, v195
    v_cos_f32 v172, v196
    v_cos_f32 v173, v197
    v_cos_f32 v174, v198
    v_cos_f32 v175, v199
    v_sin_f32 v184, v192
    v_sin_f32 v185, v193
    v_sin_f32 v186, v194
    v_sin_f32 v187, v195
    v_sin_f32 v188, v196
    v_sin_f32 v189, v197
    v_sin_f32 v190, v198
    v_sin_f32 v191, v199
    v_cvt_pk_bf16_f32 v16, v160, v161
    v_cvt_pk_bf16_f32 v17, v162, v163
    v_cvt_pk_bf16_f32 v18, v164, v165
    v_cvt_pk_bf16_f32 v19, v166, v167
    v_cvt_pk_bf16_f32 v20, v168, v169
    v_cvt_pk_bf16_f32 v21, v170, v171
    v_cvt_pk_bf16_f32 v22, v172, v173
    v_cvt_pk_bf16_f32 v23, v174, v175
    v_cvt_pk_bf16_f32 v24, v160, -v177
    v_cvt_pk_bf16_f32 v25, -v162, v179
    v_cvt_pk_bf16_f32 v26, v164, -v181
    v_cvt_pk_bf16_f32 v27, -v166, v183
    v_cvt_pk_bf16_f32 v28, v168, -v185
    v_cvt_pk_bf16_f32 v29, -v170, v187
    v_cvt_pk_bf16_f32 v30, v172, -v189
    v_cvt_pk_bf16_f32 v31, -v174, v191
    v_cvt_pk_bf16_f32 v32, v176, v177
    v_cvt_pk_bf16_f32 v33, v178, v179
    v_cvt_pk_bf16_f32 v34, v180, v181
    v_cvt_pk_bf16_f32 v35, v182, v183
    v_cvt_pk_bf16_f32 v36, v184, v185
    v_cvt_pk_bf16_f32 v37, v186, v187
    v_cvt_pk_bf16_f32 v38, v188, v189
    v_cvt_pk_bf16_f32 v39, v190, v191
    v_cvt_pk_bf16_f32 v40, v176, v161
    v_cvt_pk_bf16_f32 v41, -v178, -v163
    v_cvt_pk_bf16_f32 v42, v180, v165
    v_cvt_pk_bf16_f32 v43, -v182, -v167
    v_cvt_pk_bf16_f32 v44, v184, v169
    v_cvt_pk_bf16_f32 v45, -v186, -v171
    v_cvt_pk_bf16_f32 v46, v188, v173
    v_cvt_pk_bf16_f32 v47, -v190, -v175
    v_cvt_pk_bf16_f32 v48, -v176, -v177
    v_cvt_pk_bf16_f32 v49, -v178, -v179
    v_cvt_pk_bf16_f32 v50, -v180, -v181
    v_cvt_pk_bf16_f32 v51, -v182, -v183
    v_cvt_pk_bf16_f32 v52, -v184, -v185
    v_cvt_pk_bf16_f32 v53, -v186, -v187
    v_cvt_pk_bf16_f32 v54, -v188, -v189
    v_cvt_pk_bf16_f32 v55, -v190, -v191
    v_cvt_pk_bf16_f32 v56, -v176, -v161
    v_cvt_pk_bf16_f32 v57, v178, v163
    v_cvt_pk_bf16_f32 v58, -v180, -v165
    v_cvt_pk_bf16_f32 v59, v182, v167
    v_cvt_pk_bf16_f32 v60, -v184, -v169
    v_cvt_pk_bf16_f32 v61, v186, v171
    v_cvt_pk_bf16_f32 v62, -v188, -v173
    v_cvt_pk_bf16_f32 v63, v190, v175
    ds_write_b128 v252, a[0:3]
    ds_write_b128 v253, a[4:7]
    s_cmp_ge_u32 s44, 3
    s_cbranch_scc1 Lp1w_13
    ds_write_b128 v254, a[8:11]
    v_accvgpr_read_b32 v10, a25
    ds_write_b128 v10, a[12:15]
Lp1w_13:
    s_waitcnt lgkmcnt(0)
    s_barrier
    s_cmp_eq_u32 s44, 0
    s_cbranch_scc1 Lp1e_14
    v_and_b32 v4, 1, v3
    v_mul_u32_u24 v4, 9344, v4
    v_lshrrev_b32 v5, 1, v3
    v_lshlrev_b32 v5, 2, v5
    v_lshrrev_b32 v6, 2, v2
    v_add_u32 v5, v5, v6
    v_mul_u32_u24 v5, 288, v5
    v_add_u32 v4, v4, v5
    v_and_b32 v6, 3, v2
    v_lshlrev_b32 v6, 3, v6
    v_add_u32 v4, v4, v6
    v_add_u32 v4, 32768, v4
    s_and_b32 s54, s2, 15
    s_mul_i32 s54, s54, 196
    s_lshr_b32 s53, s2, 4
    s_lshl_b32 s53, s53, 1
    s_add_u32 s54, s54, s53
    s_lshl_b32 s54, s54, 10
    s_add_u32 s54, s54, 0x900000
    v_lshlrev_b32 v5, 4, v1
    s_add_u32 s52, s44, -1
    s_and_b32 s53, s52, 1
    s_lshr_b32 s52, s52, 1
    s_mul_i32 s55, s53, 2304
    s_lshl_b32 s61, s52, 5
    s_add_u32 s55, s55, s61
    v_add_u32 v6, s55, v4
    ds_read_b64_tr_b16 v[64:65], v6
    ds_read_b64_tr_b16 v[66:67], v6 offset:4608
    s_mul_i32 s52, s52, 28
    s_add_u32 s52, s52, s53
    s_lshl_b32 s52, s52, 10
    s_add_u32 s62, s52, s54
    s_add_u32 s52, s44, 2
    s_and_b32 s53, s52, 1
    s_lshr_b32 s52, s52, 1
    s_mul_i32 s55, s53, 2304
    s_lshl_b32 s61, s52, 5
    s_add_u32 s55, s55, s61
    v_add_u32 v6, s55, v4
    ds_read_b64_tr_b16 v[68:69], v6
    ds_read_b64_tr_b16 v[70:71], v6 offset:4608
    s_mul_i32 s52, s52, 28
    s_add_u32 s52, s52, s53
    s_lshl_b32 s52, s52, 10
    s_add_u32 s63, s52, s54
    s_add_u32 s52, s44, 5
    s_and_b32 s53, s52, 1
    s_lshr_b32 s52, s52, 1
    s_mul_i32 s55, s53, 2304
    s_lshl_b32 s61, s52, 5
    s_add_u32 s55, s55, s61
    v_add_u32 v6, s55, v4
    ds_read_b64_tr_b16 v[72:73], v6
    ds_read_b64_tr_b16 v[74:75], v6 offset:4608
    s_mul_i32 s52, s52, 28
    s_add_u32 s52, s52, s53
    s_lshl_b32 s52, s52, 10
    s_add_u32 s88, s52, s54
    s_add_u32 s52, s44, 8
    s_and_b32 s53, s52, 1
    s_lshr_b32 s52, s52, 1
    s_mul_i32 s55, s53, 2304
    s_lshl_b32 s61, s52, 5
    s_add_u32 s55, s55, s61
    v_add_u32 v6, s55, v4
    ds_read_b64_tr_b16 v[76:77], v6
    ds_read_b64_tr_b16 v[78:79], v6 offset:4608
    s_mul_i32 s52, s52, 28
    s_add_u32 s52, s52, s53
    s_lshl_b32 s52, s52, 10
    s_add_u32 s89, s52, s54
    s_add_u32 s52, s44, 11
    s_cmp_ge_u32 s52, 14
    s_cbranch_scc1 Lp1l_15
    s_and_b32 s53, s52, 1
    s_lshr_b32 s52, s52, 1
    s_mul_i32 s55, s53, 2304
    s_lshl_b32 s61, s52, 5
    s_add_u32 s55, s55, s61
    v_add_u32 v6, s55, v4
    ds_read_b64_tr_b16 v[80:81], v6
    ds_read_b64_tr_b16 v[82:83], v6 offset:4608
    s_mul_i32 s52, s52, 28
    s_add_u32 s52, s52, s53
    s_lshl_b32 s52, s52, 10
    s_add_u32 s90, s52, s54
Lp1l_15:
    s_waitcnt lgkmcnt(0)
    buffer_store_dwordx4 v[64:67], v5, s[12:15], s62 offen sc1
    buffer_store_dwordx4 v[68:71], v5, s[12:15], s63 offen sc1
    buffer_store_dwordx4 v[72:75], v5, s[12:15], s88 offen sc1
    buffer_store_dwordx4 v[76:79], v5, s[12:15], s89 offen sc1
    s_cmp_ge_u32 s44, 3
    s_cbranch_scc1 Lp1e_14
    buffer_store_dwordx4 v[80:83], v5, s[12:15], s90 offen sc1
Lp1e_14:
    s_mul_i32 s60, s56, 14
    s_add_u32 s60, s60, s57
    s_lshl_b32 s60, s60, 12
    s_add_u32 s60, s60, 0x0
    v_lshlrev_b32 v11, 8, v3
    v_lshlrev_b32 v10, 2, v2
    v_add_u32 v11, v11, v10
    s_cmp_lg_u32 s44, 0
    s_cbranch_scc1 Lpollskip_16
    v_and_b32 v5, 7, v1
    v_lshrrev_b32 v6, 3, v1
    v_lshlrev_b32 v6, 5, v6
    v_add_u32 v5, v5, v6
    s_lshl_b32 s53, s59, 3
    v_add_u32 v5, s53, v5
    v_lshlrev_b32 v5, 6, v5
    s_add_u32 s52, s48, 0x1800000
    s_mov_b32 s51, 0
    s_waitcnt vmcnt(0)
Lpoll_17:
    buffer_load_dword v232, v5, s[12:15], s52 offen sc1
    s_waitcnt vmcnt(0)
    v_xor_b32 v6, s47, v232
    v_cmp_ne_u32 vcc, 0, v6
    s_nop 4
    s_cbranch_vccz Lpolldone_18
    s_add_u32 s51, s51, 1
    s_cmp_lt_u32 s51, 100000
    s_cbranch_scc1 Lpoll_17
Lpolldone_18:
    s_mov_b64 exec, -1
Lpollskip_16:
    s_barrier
    s_xor_b32 s52, s58, 0
    s_lshl_b32 s52, s52, 11
    s_add_u32 s52, s52, s60
    buffer_load_dword v64, v11, s[12:15], s52 offen offset:0 sc1
    buffer_load_dword v65, v11, s[12:15], s52 offen offset:64 sc1
    buffer_load_dword v66, v11, s[12:15], s52 offen offset:128 sc1
    buffer_load_dword v67, v11, s[12:15], s52 offen offset:192 sc1
    buffer_load_dword v68, v11, s[12:15], s52 offen offset:1024 sc1
    buffer_load_dword v69, v11, s[12:15], s52 offen offset:1088 sc1
    buffer_load_dword v70, v11, s[12:15], s52 offen offset:1152 sc1
    buffer_load_dword v71, v11, s[12:15], s52 offen offset:1216 sc1
    s_xor_b32 s52, s58, 1
    s_lshl_b32 s52, s52, 11
    s_add_u32 s52, s52, s60
    buffer_load_dword v72, v11, s[12:15], s52 offen offset:0 sc1
    buffer_load_dword v73, v11, s[12:15], s52 offen offset:64 sc1
    buffer_load_dword v74, v11, s[12:15], s52 offen offset:128 sc1
    buffer_load_dword v75, v11, s[12:15], s52 offen offset:192 sc1
    buffer_load_dword v76, v11, s[12:15], s52 offen offset:1024 sc1
    buffer_load_dword v77, v11, s[12:15], s52 offen offset:1088 sc1
    buffer_load_dword v78, v11, s[12:15], s52 offen offset:1152 sc1
    buffer_load_dword v79, v11, s[12:15], s52 offen offset:1216 sc1
    v_cvt_f32_u32 v7, v3
    v_add_u32 v8, 0, v2
    v_lshlrev_b32 v8, 6, v8
    v_add_u32 v8, s45, v8
    v_cvt_f32_u32 v8, v8
    v_mul_f32 v8, 0x3a000000, v8
    v_mul_f32 v9, v7, v8
    v_mov_b32 v112, v9
    v_fmamk_f32 v113, v8, 0x40800000, v9
    v_fmamk_f32 v114, v8, 0x41000000, v9
    v_fmamk_f32 v115, v8, 0x41400000, v9
    v_fmamk_f32 v116, v8, 0x41800000, v9
    v_fmamk_f32 v117, v8, 0x41a00000, v9
    v_fmamk_f32 v118, v8, 0x41c00000, v9
    v_fmamk_f32 v119, v8, 0x41e00000, v9
    v_cos_f32 v120, v112
    v_cos_f32 v121, v113
    v_cos_f32 v122, v114
    v_cos_f32 v123, v115
    v_cos_f32 v124, v116
    v_cos_f32 v125, v117
    v_cos_f32 v126, v118
    v_cos_f32 v127, v119
    v_sin_f32 v128, v112
    v_sin_f32 v129, v113
    v_sin_f32 v130, v114
    v_sin_f32 v131, v115
    v_sin_f32 v132, v116
    v_sin_f32 v133, v117
    v_sin_f32 v134, v118
    v_sin_f32 v135, v119
    v_mul_f32 v120, 0x36124925, v120
    v_mul_f32 v121, 0x36124925, v121
    v_mul_f32 v122, 0x36124925, v122
    v_mul_f32 v123, 0x36124925, v123
    v_mul_f32 v124, 0x36124925, v124
    v_mul_f32 v125, 0x36124925, v125
    v_mul_f32 v126, 0x36124925, v126
    v_mul_f32 v127, 0x36124925, v127
    v_mul_f32 v128, 0x36124925, v128
    v_mul_f32 v129, 0x36124925, v129
    v_mul_f32 v130, 0x36124925, v130
    v_mul_f32 v131, 0x36124925, v131
    v_mul_f32 v132, 0x36124925, v132
    v_mul_f32 v133, 0x36124925, v133
    v_mul_f32 v134, 0x36124925, v134
    v_mul_f32 v135, 0x36124925, v135
    v_cvt_pk_bf16_f32 v220, v120, -v128
    v_cvt_pk_bf16_f32 v236, v128, v120
    v_cvt_pk_bf16_f32 v221, v121, -v129
    v_cvt_pk_bf16_f32 v237, v129, v121
    v_cvt_pk_bf16_f32 v222, v122, -v130
    v_cvt_pk_bf16_f32 v238, v130, v122
    v_cvt_pk_bf16_f32 v223, v123, -v131
    v_cvt_pk_bf16_f32 v239, v131, v123
    v_cvt_pk_bf16_f32 v228, v124, -v132
    v_cvt_pk_bf16_f32 v244, v132, v124
    v_cvt_pk_bf16_f32 v229, v125, -v133
    v_cvt_pk_bf16_f32 v245, v133, v125
    v_cvt_pk_bf16_f32 v230, v126, -v134
    v_cvt_pk_bf16_f32 v246, v134, v126
    v_cvt_pk_bf16_f32 v231, v127, -v135
    v_cvt_pk_bf16_f32 v247, v135, v127
    v_add_u32 v8, 16, v2
    v_lshlrev_b32 v8, 6, v8
    v_add_u32 v8, s45, v8
    v_cvt_f32_u32 v8, v8
    v_mul_f32 v8, 0x3a000000, v8
    v_mul_f32 v9, v7, v8
    v_mov_b32 v112, v9
    v_fmamk_f32 v113, v8, 0x40800000, v9
    v_fmamk_f32 v114, v8, 0x41000000, v9
    v_fmamk_f32 v115, v8, 0x41400000, v9
    v_fmamk_f32 v116, v8, 0x41800000, v9
    v_fmamk_f32 v117, v8, 0x41a00000, v9
    v_fmamk_f32 v118, v8, 0x41c00000, v9
    v_fmamk_f32 v119, v8, 0x41e00000, v9
    v_cos_f32 v120, v112
    v_cos_f32 v121, v113
    v_cos_f32 v122, v114
    v_cos_f32 v123, v115
    v_cos_f32 v124, v116
    v_cos_f32 v125, v117
    v_cos_f32 v126, v118
    v_cos_f32 v127, v119
    v_sin_f32 v128, v112
    v_sin_f32 v129, v113
    v_sin_f32 v130, v114
    v_sin_f32 v131, v115
    v_sin_f32 v132, v116
    v_sin_f32 v133, v117
    v_sin_f32 v134, v118
    v_sin_f32 v135, v119
    v_mul_f32 v120, 0x36124925, v120
    v_mul_f32 v121, 0x36124925, v121
    v_mul_f32 v122, 0x36124925, v122
    v_mul_f32 v123, 0x36124925, v123
    v_mul_f32 v124, 0x36124925, v124
    v_mul_f32 v125, 0x36124925, v125
    v_mul_f32 v126, 0x36124925, v126
    v_mul_f32 v127, 0x36124925, v127
    v_mul_f32 v128, 0x36124925, v128
    v_mul_f32 v129, 0x36124925, v129
    v_mul_f32 v130, 0x36124925, v130
    v_mul_f32 v131, 0x36124925, v131
    v_mul_f32 v132, 0x36124925, v132
    v_mul_f32 v133, 0x36124925, v133
    v_mul_f32 v134, 0x36124925, v134
    v_mul_f32 v135, 0x36124925, v135
    v_cvt_pk_bf16_f32 v224, v120, -v128
    v_cvt_pk_bf16_f32 v240, v128, v120
    v_cvt_pk_bf16_f32 v225, v121, -v129
    v_cvt_pk_bf16_f32 v241, v129, v121
    v_cvt_pk_bf16_f32 v226, v122, -v130
    v_cvt_pk_bf16_f32 v242, v130, v122
    v_cvt_pk_bf16_f32 v227, v123, -v131
    v_cvt_pk_bf16_f32 v243, v131, v123
    v_cvt_pk_bf16_f32 v232, v124, -v132
    v_cvt_pk_bf16_f32 v248, v132, v124
    v_cvt_pk_bf16_f32 v233, v125, -v133
    v_cvt_pk_bf16_f32 v249, v133, v125
    v_cvt_pk_bf16_f32 v234, v126, -v134
    v_cvt_pk_bf16_f32 v250, v134, v126
    v_cvt_pk_bf16_f32 v235, v127, -v135
    v_cvt_pk_bf16_f32 v251, v135, v127
    s_mov_b32 s52, 0x05040100
    s_mov_b32 s53, 0x07060302
    s_waitcnt vmcnt(8)
    v_perm_b32 v80, v65, v64, s52
    v_perm_b32 v88, v65, v64, s53
    v_perm_b32 v81, v67, v66, s52
    v_perm_b32 v89, v67, v66, s53
    v_perm_b32 v82, v69, v68, s52
    v_perm_b32 v90, v69, v68, s53
    v_perm_b32 v83, v71, v70, s52
    v_perm_b32 v91, v71, v70, s53
    s_waitcnt vmcnt(0)
    v_perm_b32 v84, v73, v72, s52
    v_perm_b32 v92, v73, v72, s53
    v_perm_b32 v85, v75, v74, s52
    v_perm_b32 v93, v75, v74, s53
    v_perm_b32 v86, v77, v76, s52
    v_perm_b32 v94, v77, v76, s53
    v_perm_b32 v87, v79, v78, s52
    v_perm_b32 v95, v79, v78, s53
    v_mfma_f32_16x16x32_bf16 v[112:115], v[16:19], v[80:83], 0
    v_mfma_f32_16x16x32_bf16 v[116:119], v[48:51], v[80:83], 0
    v_mfma_f32_16x16x32_bf16 v[120:123], v[24:27], v[80:83], 0
    v_mfma_f32_16x16x32_bf16 v[124:127], v[56:59], v[80:83], 0
    v_mfma_f32_16x16x32_bf16 v[112:115], v[20:23], v[84:87], v[112:115]
    v_mfma_f32_16x16x32_bf16 v[116:119], v[52:55], v[84:87], v[116:119]
    v_mfma_f32_16x16x32_bf16 v[120:123], v[28:31], v[84:87], v[120:123]
    v_mfma_f32_16x16x32_bf16 v[124:127], v[60:63], v[84:87], v[124:127]
    v_mfma_f32_16x16x32_bf16 v[112:115], v[32:35], v[88:91], v[112:115]
    v_mfma_f32_16x16x32_bf16 v[116:119], v[16:19], v[88:91], v[116:119]
    v_mfma_f32_16x16x32_bf16 v[120:123], v[40:43], v[88:91], v[120:123]
    v_mfma_f32_16x16x32_bf16 v[124:127], v[24:27], v[88:91], v[124:127]
    v_mfma_f32_16x16x32_bf16 v[112:115], v[36:39], v[92:95], v[112:115]
    v_mfma_f32_16x16x32_bf16 v[116:119], v[20:23], v[92:95], v[116:119]
    v_mfma_f32_16x16x32_bf16 v[120:123], v[44:47], v[92:95], v[120:123]
    v_mfma_f32_16x16x32_bf16 v[124:127], v[28:31], v[92:95], v[124:127]
    s_nop 4
    v_mul_f32 v128, v112, v96
    v_mul_f32 v136, v112, v104
    v_fma_f32 v128, -v116, v104, v128
    v_fma_f32 v136, v116, v96, v136
    v_mul_f32 v129, v113, v97
    v_mul_f32 v137, v113, v105
    v_fma_f32 v129, -v117, v105, v129
    v_fma_f32 v137, v117, v97, v137
    v_mul_f32 v130, v114, v98
    v_mul_f32 v138, v114, v106
    v_fma_f32 v130, -v118, v106, v130
    v_fma_f32 v138, v118, v98, v138
    v_mul_f32 v131, v115, v99
    v_mul_f32 v139, v115, v107
    v_fma_f32 v131, -v119, v107, v131
    v_fma_f32 v139, v119, v99, v139
    v_mul_f32 v132, v120, v100
    v_mul_f32 v140, v120, v108
    v_fma_f32 v132, -v124, v108, v132
    v_fma_f32 v140, v124, v100, v140
    v_mul_f32 v133, v121, v101
    v_mul_f32 v141, v121, v109
    v_fma_f32 v133, -v125, v109, v133
    v_fma_f32 v141, v125, v101, v141
    v_mul_f32 v134, v122, v102
    v_mul_f32 v142, v122, v110
    v_fma_f32 v134, -v126, v110, v134
    v_fma_f32 v142, v126, v102, v142
    v_mul_f32 v135, v123, v103
    v_mul_f32 v143, v123, v111
    v_fma_f32 v135, -v127, v111, v135
    v_fma_f32 v143, v127, v103, v143
    v_cvt_pk_bf16_f32 v144, v128, v129
    v_cvt_pk_bf16_f32 v145, v130, v131
    v_cvt_pk_bf16_f32 v146, v132, v133
    v_cvt_pk_bf16_f32 v147, v134, v135
    v_cvt_pk_bf16_f32 v152, v136, v137
    v_cvt_pk_bf16_f32 v153, v138, v139
    v_cvt_pk_bf16_f32 v154, v140, v141
    v_cvt_pk_bf16_f32 v155, v142, v143
    v_lshlrev_b32 v10, 4, v1
    s_lshl_b32 s52, s44, 11
    v_add_u32 v12, s52, v10
    s_xor_b32 s52, s44, 1
    s_lshl_b32 s52, s52, 11
    v_add_u32 v13, s52, v10
    ds_write_b128 v12, v[144:147]
    ds_write_b128 v12, v[152:155] offset:1024
    s_waitcnt lgkmcnt(0)
    s_barrier
    ds_read_b128 v[148:151], v13
    ds_read_b128 v[156:159], v13 offset:1024
    v_mfma_f32_16x16x32_bf16 v[112:115], v[16:19], v[144:147], 0
    v_mfma_f32_16x16x32_bf16 v[116:119], v[32:35], v[144:147], 0
    v_mfma_f32_16x16x32_bf16 v[112:115], v[48:51], v[152:155], v[112:115]
    v_mfma_f32_16x16x32_bf16 v[116:119], v[16:19], v[152:155], v[116:119]
    v_mfma_f32_16x16x32_bf16 v[120:123], v[24:27], v[144:147], 0
    v_mfma_f32_16x16x32_bf16 v[124:127], v[40:43], v[144:147], 0
    v_mfma_f32_16x16x32_bf16 v[120:123], v[56:59], v[152:155], v[120:123]
    v_mfma_f32_16x16x32_bf16 v[124:127], v[24:27], v[152:155], v[124:127]
    s_waitcnt lgkmcnt(0)
    v_mfma_f32_16x16x32_bf16 v[112:115], v[20:23], v[148:151], v[112:115]
    v_mfma_f32_16x16x32_bf16 v[116:119], v[36:39], v[148:151], v[116:119]
    v_mfma_f32_16x16x32_bf16 v[112:115], v[52:55], v[156:159], v[112:115]
    v_mfma_f32_16x16x32_bf16 v[116:119], v[20:23], v[156:159], v[116:119]
    v_mfma_f32_16x16x32_bf16 v[120:123], v[28:31], v[148:151], v[120:123]
    v_mfma_f32_16x16x32_bf16 v[124:127], v[44:47], v[148:151], v[124:127]
    v_mfma_f32_16x16x32_bf16 v[120:123], v[60:63], v[156:159], v[120:123]
    v_mfma_f32_16x16x32_bf16 v[124:127], v[28:31], v[156:159], v[124:127]
    s_mov_b32 s52, 114688
    v_mul_lo_u32 v4, v3, s52
    v_lshlrev_b32 v5, 2, v2
    v_add_u32 v4, v4, v5
    s_lshl_b32 s52, s57, 11
    s_lshl_b32 s53, s56, 6
    s_add_u32 s52, s52, s53
    s_mul_i32 s53, s58, 917504
    s_add_u32 s52, s52, s53
    v_cvt_pk_bf16_f32 v64, v112, v116
    v_cvt_pk_bf16_f32 v65, v113, v117
    v_cvt_pk_bf16_f32 v66, v114, v118
    v_cvt_pk_bf16_f32 v67, v115, v119
    s_add_u32 s53, s52, 2097152
    buffer_store_dword v64, v4, s[12:15], s53 offen sc1
    s_add_u32 s53, s52, 2125824
    buffer_store_dword v65, v4, s[12:15], s53 offen sc1
    s_add_u32 s53, s52, 2154496
    buffer_store_dword v66, v4, s[12:15], s53 offen sc1
    s_add_u32 s53, s52, 2183168
    buffer_store_dword v67, v4, s[12:15], s53 offen sc1
    v_cvt_pk_bf16_f32 v68, v120, v124
    v_cvt_pk_bf16_f32 v69, v121, v125
    v_cvt_pk_bf16_f32 v70, v122, v126
    v_cvt_pk_bf16_f32 v71, v123, v127
    s_add_u32 s53, s52, 2555904
    buffer_store_dword v68, v4, s[12:15], s53 offen sc1
    s_add_u32 s53, s52, 2584576
    buffer_store_dword v69, v4, s[12:15], s53 offen sc1
    s_add_u32 s53, s52, 2613248
    buffer_store_dword v70, v4, s[12:15], s53 offen sc1
    s_add_u32 s53, s52, 2641920
    buffer_store_dword v71, v4, s[12:15], s53 offen sc1
    s_waitcnt vmcnt(0)
    s_branch Ljoin_11
Lp2_10:
    s_barrier
    s_cmp_lg_u32 s44, 0
    s_cbranch_scc1 Lsig_19
    s_lshl_b32 s52, s2, 6
    s_add_u32 s52, s52, 0x1840000
    v_mov_b32 v14, s47
    v_lshlrev_b32 v15, 14, v1
    s_mov_b64 exec, 0xff
    buffer_store_dword v14, v15, s[12:15], s52 offen sc1
    s_mov_b64 exec, -1
Lsig_19:
    s_cmp_ge_u32 s2, 252
    s_cbranch_scc1 Lp2none_21
    s_sub_u32 s56, s2, 224
    s_waitcnt vmcnt(0)
    s_barrier
    s_mul_i32 s52, s56, 57344
    v_lshlrev_b32 v4, 4, v0
    s_mov_b32 s57, s52
    s_add_u32 s53, s57, 0
    buffer_load_dwordx4 v[16:19], v4, s[32:35], s53 offen
    s_add_u32 s53, s57, 4096
    buffer_load_dwordx4 v[20:23], v4, s[32:35], s53 offen
    s_add_u32 s53, s57, 8192
    buffer_load_dwordx4 v[24:27], v4, s[32:35], s53 offen
    s_add_u32 s53, s57, 12288
    buffer_load_dwordx4 v[28:31], v4, s[32:35], s53 offen
    s_add_u32 s53, s57, 16384
    buffer_load_dwordx4 v[32:35], v4, s[32:35], s53 offen
    s_add_u32 s53, s57, 20480
    buffer_load_dwordx4 v[36:39], v4, s[32:35], s53 offen
    s_add_u32 s53, s57, 24576
    buffer_load_dwordx4 v[40:43], v4, s[32:35], s53 offen
    s_add_u32 s53, s57, 28672
    buffer_load_dwordx4 v[44:47], v4, s[32:35], s53 offen
    v_add_u32 v5, 0, v0
    v_mul_u32_u24 v6, 18725, v5
    v_lshrrev_b32 v6, 20, v6
    v_lshlrev_b32 v6, 5, v6
    v_lshlrev_b32 v5, 4, v5
    v_add_u32 v80, v5, v6
    v_add_u32 v80, 32768, v80
    v_add_u32 v5, 256, v0
    v_mul_u32_u24 v6, 18725, v5
    v_lshrrev_b32 v6, 20, v6
    v_lshlrev_b32 v6, 5, v6
    v_lshlrev_b32 v5, 4, v5
    v_add_u32 v81, v5, v6
    v_add_u32 v81, 32768, v81
    v_add_u32 v5, 512, v0
    v_mul_u32_u24 v6, 18725, v5
    v_lshrrev_b32 v6, 20, v6
    v_lshlrev_b32 v6, 5, v6
    v_lshlrev_b32 v5, 4, v5
    v_add_u32 v82, v5, v6
    v_add_u32 v82, 32768, v82
    v_add_u32 v5, 768, v0
    v_mul_u32_u24 v6, 18725, v5
    v_lshrrev_b32 v6, 20, v6
    v_lshlrev_b32 v6, 5, v6
    v_lshlrev_b32 v5, 4, v5
    v_add_u32 v83, v5, v6
    v_add_u32 v83, 32768, v83
    v_add_u32 v5, 1024, v0
    v_mul_u32_u24 v6, 18725, v5
    v_lshrrev_b32 v6, 20, v6
    v_lshlrev_b32 v6, 5, v6
    v_lshlrev_b32 v5, 4, v5
    v_add_u32 v84, v5, v6
    v_add_u32 v84, 32768, v84
    v_add_u32 v5, 1280, v0
    v_mul_u32_u24 v6, 18725, v5
    v_lshrrev_b32 v6, 20, v6
    v_lshlrev_b32 v6, 5, v6
    v_lshlrev_b32 v5, 4, v5
    v_add_u32 v85, v5, v6
    v_add_u32 v85, 32768, v85
    v_add_u32 v5, 1536, v0
    v_mul_u32_u24 v6, 18725, v5
    v_lshrrev_b32 v6, 20, v6
    v_lshlrev_b32 v6, 5, v6
    v_lshlrev_b32 v5, 4, v5
    v_add_u32 v86, v5, v6
    v_add_u32 v86, 32768, v86
    v_add_u32 v5, 1792, v0
    v_mul_u32_u24 v6, 18725, v5
    v_lshrrev_b32 v6, 20, v6
    v_lshlrev_b32 v6, 5, v6
    v_lshlrev_b32 v5, 4, v5
    v_add_u32 v87, v5, v6
    v_add_u32 v87, 32768, v87
    v_add_u32 v5, 2048, v0
    v_mul_u32_u24 v6, 18725, v5
    v_lshrrev_b32 v6, 20, v6
    v_lshlrev_b32 v6, 5, v6
    v_lshlrev_b32 v5, 4, v5
    v_add_u32 v88, v5, v6
    v_add_u32 v88, 32768, v88
    v_add_u32 v5, 2304, v0
    v_mul_u32_u24 v6, 18725, v5
    v_lshrrev_b32 v6, 20, v6
    v_lshlrev_b32 v6, 5, v6
    v_lshlrev_b32 v5, 4, v5
    v_add_u32 v89, v5, v6
    v_add_u32 v89, 32768, v89
    v_add_u32 v5, 2560, v0
    v_mul_u32_u24 v6, 18725, v5
    v_lshrrev_b32 v6, 20, v6
    v_lshlrev_b32 v6, 5, v6
    v_lshlrev_b32 v5, 4, v5
    v_add_u32 v90, v5, v6
    v_add_u32 v90, 32768, v90
    v_add_u32 v5, 2816, v0
    v_mul_u32_u24 v6, 18725, v5
    v_lshrrev_b32 v6, 20, v6
    v_lshlrev_b32 v6, 5, v6
    v_lshlrev_b32 v5, 4, v5
    v_add_u32 v91, v5, v6
    v_add_u32 v91, 32768, v91
    v_add_u32 v5, 3072, v0
    v_mul_u32_u24 v6, 18725, v5
    v_lshrrev_b32 v6, 20, v6
    v_lshlrev_b32 v6, 5, v6
    v_lshlrev_b32 v5, 4, v5
    v_add_u32 v92, v5, v6
    v_add_u32 v92, 32768, v92
    v_add_u32 v5, 3328, v0
    v_mul_u32_u24 v6, 18725, v5
    v_lshrrev_b32 v6, 20, v6
    v_lshlrev_b32 v6, 5, v6
    v_lshlrev_b32 v5, 4, v5
    v_add_u32 v93, v5, v6
    v_add_u32 v93, 32768, v93
    v_cvt_f32_u32 v7, v3
    v_add_u32 v8, 0, v2
    v_lshlrev_b32 v8, 6, v8
    v_add_u32 v8, s45, v8
    v_cvt_f32_u32 v8, v8
    v_mul_f32 v8, 0x3a000000, v8
    v_mul_f32 v9, v7, v8
    v_mov_b32 v112, v9
    v_fmamk_f32 v113, v8, 0x40800000, v9
    v_fmamk_f32 v114, v8, 0x41000000, v9
    v_fmamk_f32 v115, v8, 0x41400000, v9
    v_fmamk_f32 v116, v8, 0x41800000, v9
    v_fmamk_f32 v117, v8, 0x41a00000, v9
    v_fmamk_f32 v118, v8, 0x41c00000, v9
    v_fmamk_f32 v119, v8, 0x41e00000, v9
    v_cos_f32 v120, v112
    v_cos_f32 v121, v113
    v_cos_f32 v122, v114
    v_cos_f32 v123, v115
    v_cos_f32 v124, v116
    v_cos_f32 v125, v117
    v_cos_f32 v126, v118
    v_cos_f32 v127, v119
    v_sin_f32 v128, v112
    v_sin_f32 v129, v113
    v_sin_f32 v130, v114
    v_sin_f32 v131, v115
    v_sin_f32 v132, v116
    v_sin_f32 v133, v117
    v_sin_f32 v134, v118
    v_sin_f32 v135, v119
    v_mul_f32 v120, 0x36124925, v120
    v_mul_f32 v121, 0x36124925, v121
    v_mul_f32 v122, 0x36124925, v122
    v_mul_f32 v123, 0x36124925, v123
    v_mul_f32 v124, 0x36124925, v124
    v_mul_f32 v125, 0x36124925, v125
    v_mul_f32 v126, 0x36124925, v126
    v_mul_f32 v127, 0x36124925, v127
    v_mul_f32 v128, 0x36124925, v128
    v_mul_f32 v129, 0x36124925, v129
    v_mul_f32 v130, 0x36124925, v130
    v_mul_f32 v131, 0x36124925, v131
    v_mul_f32 v132, 0x36124925, v132
    v_mul_f32 v133, 0x36124925, v133
    v_mul_f32 v134, 0x36124925, v134
    v_mul_f32 v135, 0x36124925, v135
    v_cvt_pk_bf16_f32 v220, v120, -v128
    v_cvt_pk_bf16_f32 v236, v128, v120
    v_cvt_pk_bf16_f32 v221, v121, -v129
    v_cvt_pk_bf16_f32 v237, v129, v121
    v_cvt_pk_bf16_f32 v222, v122, -v130
    v_cvt_pk_bf16_f32 v238, v130, v122
    v_cvt_pk_bf16_f32 v223, v123, -v131
    v_cvt_pk_bf16_f32 v239, v131, v123
    v_cvt_pk_bf16_f32 v228, v124, -v132
    v_cvt_pk_bf16_f32 v244, v132, v124
    v_cvt_pk_bf16_f32 v229, v125, -v133
    v_cvt_pk_bf16_f32 v245, v133, v125
    v_cvt_pk_bf16_f32 v230, v126, -v134
    v_cvt_pk_bf16_f32 v246, v134, v126
    v_cvt_pk_bf16_f32 v231, v127, -v135
    v_cvt_pk_bf16_f32 v247, v135, v127
    v_add_u32 v8, 16, v2
    v_lshlrev_b32 v8, 6, v8
    v_add_u32 v8, s45, v8
    v_cvt_f32_u32 v8, v8
    v_mul_f32 v8, 0x3a000000, v8
    v_mul_f32 v9, v7, v8
    v_mov_b32 v112, v9
    v_fmamk_f32 v113, v8, 0x40800000, v9
    v_fmamk_f32 v114, v8, 0x41000000, v9
    v_fmamk_f32 v115, v8, 0x41400000, v9
    v_fmamk_f32 v116, v8, 0x41800000, v9
    v_fmamk_f32 v117, v8, 0x41a00000, v9
    v_fmamk_f32 v118, v8, 0x41c00000, v9
    v_fmamk_f32 v119, v8, 0x41e00000, v9
    v_cos_f32 v120, v112
    v_cos_f32 v121, v113
    v_cos_f32 v122, v114
    v_cos_f32 v123, v115
    v_cos_f32 v124, v116
    v_cos_f32 v125, v117
    v_cos_f32 v126, v118
    v_cos_f32 v127, v119
    v_sin_f32 v128, v112
    v_sin_f32 v129, v113
    v_sin_f32 v130, v114
    v_sin_f32 v131, v115
    v_sin_f32 v132, v116
    v_sin_f32 v133, v117
    v_sin_f32 v134, v118
    v_sin_f32 v135, v119
    v_mul_f32 v120, 0x36124925, v120
    v_mul_f32 v121, 0x36124925, v121
    v_mul_f32 v122, 0x36124925, v122
    v_mul_f32 v123, 0x36124925, v123
    v_mul_f32 v124, 0x36124925, v124
    v_mul_f32 v125, 0x36124925, v125
    v_mul_f32 v126, 0x36124925, v126
    v_mul_f32 v127, 0x36124925, v127
    v_mul_f32 v128, 0x36124925, v128
    v_mul_f32 v129, 0x36124925, v129
    v_mul_f32 v130, 0x36124925, v130
    v_mul_f32 v131, 0x36124925, v131
    v_mul_f32 v132, 0x36124925, v132
    v_mul_f32 v133, 0x36124925, v133
    v_mul_f32 v134, 0x36124925, v134
    v_mul_f32 v135, 0x36124925, v135
    v_cvt_pk_bf16_f32 v224, v120, -v128
    v_cvt_pk_bf16_f32 v240, v128, v120
    v_cvt_pk_bf16_f32 v225, v121, -v129
    v_cvt_pk_bf16_f32 v241, v129, v121
    v_cvt_pk_bf16_f32 v226, v122, -v130
    v_cvt_pk_bf16_f32 v242, v130, v122
    v_cvt_pk_bf16_f32 v227, v123, -v131
    v_cvt_pk_bf16_f32 v243, v131, v123
    v_cvt_pk_bf16_f32 v232, v124, -v132
    v_cvt_pk_bf16_f32 v248, v132, v124
    v_cvt_pk_bf16_f32 v233, v125, -v133
    v_cvt_pk_bf16_f32 v249, v133, v125
    v_cvt_pk_bf16_f32 v234, v126, -v134
    v_cvt_pk_bf16_f32 v250, v134, v126
    v_cvt_pk_bf16_f32 v235, v127, -v135
    v_cvt_pk_bf16_f32 v251, v135, v127
    s_add_u32 s53, s57, 32768
    buffer_load_dwordx4 v[48:51], v4, s[32:35], s53 offen
    s_add_u32 s53, s57, 36864
    buffer_load_dwordx4 v[52:55], v4, s[32:35], s53 offen
    s_add_u32 s53, s57, 40960
    buffer_load_dwordx4 v[56:59], v4, s[32:35], s53 offen
    s_add_u32 s53, s57, 45056
    buffer_load_dwordx4 v[60:63], v4, s[32:35], s53 offen
    s_add_u32 s53, s57, 49152
    buffer_load_dwordx4 v[64:67], v4, s[32:35], s53 offen
    s_add_u32 s53, s57, 53248
    buffer_load_dwordx4 v[68:71], v4, s[32:35], s53 offen
    s_lshl_b32 s61, s46, 2
    s_add_u32 s61, s61, s44
    s_min_u32 s61, s61, 13
    s_lshl_b32 s61, s61, 4
    v_add_u32 v8, s61, v2
    v_cvt_f32_u32 v8, v8
    v_mul_f32 v8, 0x3b124925, v8
    v_lshlrev_b32 v9, 3, v3
    v_cvt_f32_u32 v9, v9
    v_mul_f32 v9, v9, v8
    v_cmp_eq_u32 vcc, 3, v3
    v_mov_b32 v10, 1.0
    v_mov_b32 v7, 0.5
    v_cndmask_b32 v10, v10, v7, vcc
    v_mul_f32 v7, 0x42000000, v8
    v_fmamk_f32 v112, v8, 0x40000000, v9
    v_fmamk_f32 v113, v8, 0x40800000, v9
    v_fmamk_f32 v114, v8, 0x40c00000, v9
    v_fmamk_f32 v115, v8, 0x41000000, v9
    v_fmamk_f32 v116, v8, 0x3f800000, v9
    v_fmamk_f32 v117, v8, 0x40400000, v9
    v_fmamk_f32 v118, v8, 0x40a00000, v9
    v_fmamk_f32 v119, v8, 0x40e00000, v9
    v_cos_f32 v12, v7
    v_sin_f32 v13, v7
    v_cos_f32 v120, v112
    v_cos_f32 v121, v113
    v_cos_f32 v122, v114
    v_cos_f32 v123, v115
    v_cos_f32 v124, v116
    v_cos_f32 v125, v117
    v_cos_f32 v126, v118
    v_cos_f32 v127, v119
    v_sin_f32_e64 v128, -v112
    v_sin_f32_e64 v129, -v113
    v_sin_f32_e64 v130, -v114
    v_sin_f32_e64 v131, -v115
    v_sin_f32_e64 v132, -v116
    v_sin_f32_e64 v133, -v117
    v_sin_f32_e64 v134, -v118
    v_sin_f32_e64 v135, -v119
    v_pk_mul_f32 v[136:137], v[120:121], v[12:13] op_sel:[0,0] op_sel_hi:[1,0]
    v_pk_mul_f32 v[144:145], v[128:129], v[12:13] op_sel:[0,0] op_sel_hi:[1,0]
    v_pk_mul_f32 v[138:139], v[122:123], v[12:13] op_sel:[0,0] op_sel_hi:[1,0]
    v_pk_mul_f32 v[146:147], v[130:131], v[12:13] op_sel:[0,0] op_sel_hi:[1,0]
    v_pk_mul_f32 v[140:141], v[124:125], v[12:13] op_sel:[0,0] op_sel_hi:[1,0]
    v_pk_mul_f32 v[148:149], v[132:133], v[12:13] op_sel:[0,0] op_sel_hi:[1,0]
    v_pk_mul_f32 v[142:143], v[126:127], v[12:13] op_sel:[0,0] op_sel_hi:[1,0]
    v_pk_mul_f32 v[150:151], v[134:135], v[12:13] op_sel:[0,0] op_sel_hi:[1,0]
    v_pk_fma_f32 v[136:137], v[128:129], v[12:13], v[136:137] op_sel:[0,1,0] op_sel_hi:[1,1,1]
    v_pk_fma_f32 v[144:145], v[120:121], v[12:13], v[144:145] op_sel:[0,1,0] op_sel_hi:[1,1,1] neg_lo:[0,1,0] neg_hi:[0,1,0]
    v_pk_fma_f32 v[138:139], v[130:131], v[12:13], v[138:139] op_sel:[0,1,0] op_sel_hi:[1,1,1]
    v_pk_fma_f32 v[146:147], v[122:123], v[12:13], v[146:147] op_sel:[0,1,0] op_sel_hi:[1,1,1] neg_lo:[0,1,0] neg_hi:[0,1,0]
    v_pk_fma_f32 v[140:141], v[132:133], v[12:13], v[140:141] op_sel:[0,1,0] op_sel_hi:[1,1,1]
    v_pk_fma_f32 v[148:149], v[124:125], v[12:13], v[148:149] op_sel:[0,1,0] op_sel_hi:[1,1,1] neg_lo:[0,1,0] neg_hi:[0,1,0]
    v_pk_fma_f32 v[142:143], v[134:135], v[12:13], v[142:143] op_sel:[0,1,0] op_sel_hi:[1,1,1]
    v_pk_fma_f32 v[150:151], v[126:127], v[12:13], v[150:151] op_sel:[0,1,0] op_sel_hi:[1,1,1] neg_lo:[0,1,0] neg_hi:[0,1,0]
    v_cvt_pk_bf16_f32 v160, v120, v121
    v_cvt_pk_bf16_f32 v161, v122, v123
    v_cvt_pk_bf16_f32 v162, v128, v129
    v_cvt_pk_bf16_f32 v163, v130, v131
    v_cvt_pk_bf16_f32 v188, v124, v125
    v_cvt_pk_bf16_f32 v189, v126, v127
    v_cvt_pk_bf16_f32 v190, v132, v133
    v_cvt_pk_bf16_f32 v191, v134, v135
    v_pk_mul_f32 v[120:121], v[136:137], v[12:13] op_sel:[0,0] op_sel_hi:[1,0]
    v_pk_mul_f32 v[128:129], v[144:145], v[12:13] op_sel:[0,0] op_sel_hi:[1,0]
    v_pk_mul_f32 v[122:123], v[138:139], v[12:13] op_sel:[0,0] op_sel_hi:[1,0]
    v_pk_mul_f32 v[130:131], v[146:147], v[12:13] op_sel:[0,0] op_sel_hi:[1,0]
    v_pk_mul_f32 v[124:125], v[140:141], v[12:13] op_sel:[0,0] op_sel_hi:[1,0]
    v_pk_mul_f32 v[132:133], v[148:149], v[12:13] op_sel:[0,0] op_sel_hi:[1,0]
    v_pk_mul_f32 v[126:127], v[142:143], v[12:13] op_sel:[0,0] op_sel_hi:[1,0]
    v_pk_mul_f32 v[134:135], v[150:151], v[12:13] op_sel:[0,0] op_sel_hi:[1,0]
    v_pk_fma_f32 v[120:121], v[144:145], v[12:13], v[120:121] op_sel:[0,1,0] op_sel_hi:[1,1,1]
    v_pk_fma_f32 v[128:129], v[136:137], v[12:13], v[128:129] op_sel:[0,1,0] op_sel_hi:[1,1,1] neg_lo:[0,1,0] neg_hi:[0,1,0]
    v_pk_fma_f32 v[122:123], v[146:147], v[12:13], v[122:123] op_sel:[0,1,0] op_sel_hi:[1,1,1]
    v_pk_fma_f32 v[130:131], v[138:139], v[12:13], v[130:131] op_sel:[0,1,0] op_sel_hi:[1,1,1] neg_lo:[0,1,0] neg_hi:[0,1,0]
    v_pk_fma_f32 v[124:125], v[148:149], v[12:13], v[124:125] op_sel:[0,1,0] op_sel_hi:[1,1,1]
    v_pk_fma_f32 v[132:133], v[140:141], v[12:13], v[132:133] op_sel:[0,1,0] op_sel_hi:[1,1,1] neg_lo:[0,1,0] neg_hi:[0,1,0]
    v_pk_fma_f32 v[126:127], v[150:151], v[12:13], v[126:127] op_sel:[0,1,0] op_sel_hi:[1,1,1]
    v_pk_fma_f32 v[134:135], v[142:143], v[12:13], v[134:135] op_sel:[0,1,0] op_sel_hi:[1,1,1] neg_lo:[0,1,0] neg_hi:[0,1,0]
    v_cvt_pk_bf16_f32 v164, v136, v137
    v_cvt_pk_bf16_f32 v165, v138, v139
    v_cvt_pk_bf16_f32 v166, v144, v145
    v_cvt_pk_bf16_f32 v167, v146, v147
    v_cvt_pk_bf16_f32 v192, v140, v141
    v_cvt_pk_bf16_f32 v193, v142, v143
    v_cvt_pk_bf16_f32 v194, v148, v149
    v_cvt_pk_bf16_f32 v195, v150, v151
    v_pk_mul_f32 v[136:137], v[120:121], v[12:13] op_sel:[0,0] op_sel_hi:[1,0]
    v_pk_mul_f32 v[144:145], v[128:129], v[12:13] op_sel:[0,0] op_sel_hi:[1,0]
    v_pk_mul_f32 v[138:139], v[122:123], v[12:13] op_sel:[0,0] op_sel_hi:[1,0]
    v_pk_mul_f32 v[146:147], v[130:131], v[12:13] op_sel:[0,0] op_sel_hi:[1,0]
    v_pk_mul_f32 v[140:141], v[124:125], v[12:13] op_sel:[0,0] op_sel_hi:[1,0]
    v_pk_mul_f32 v[148:149], v[132:133], v[12:13] op_sel:[0,0] op_sel_hi:[1,0]
    v_pk_mul_f32 v[142:143], v[126:127], v[12:13] op_sel:[0,0] op_sel_hi:[1,0]
    v_pk_mul_f32 v[150:151], v[134:135], v[12:13] op_sel:[0,0] op_sel_hi:[1,0]
    v_pk_fma_f32 v[136:137], v[128:129], v[12:13], v[136:137] op_sel:[0,1,0] op_sel_hi:[1,1,1]
    v_pk_fma_f32 v[144:145], v[120:121], v[12:13], v[144:145] op_sel:[0,1,0] op_sel_hi:[1,1,1] neg_lo:[0,1,0] neg_hi:[0,1,0]
    v_pk_fma_f32 v[138:139], v[130:131], v[12:13], v[138:139] op_sel:[0,1,0] op_sel_hi:[1,1,1]
    v_pk_fma_f32 v[146:147], v[122:123], v[12:13], v[146:147] op_sel:[0,1,0] op_sel_hi:[1,1,1] neg_lo:[0,1,0] neg_hi:[0,1,0]
    v_pk_fma_f32 v[140:141], v[132:133], v[12:13], v[140:141] op_sel:[0,1,0] op_sel_hi:[1,1,1]
    v_pk_fma_f32 v[148:149], v[124:125], v[12:13], v[148:149] op_sel:[0,1,0] op_sel_hi:[1,1,1] neg_lo:[0,1,0] neg_hi:[0,1,0]
    v_pk_fma_f32 v[142:143], v[134:135], v[12:13], v[142:143] op_sel:[0,1,0] op_sel_hi:[1,1,1]
    v_pk_fma_f32 v[150:151], v[126:127], v[12:13], v[150:151] op_sel:[0,1,0] op_sel_hi:[1,1,1] neg_lo:[0,1,0] neg_hi:[0,1,0]
    v_cvt_pk_bf16_f32 v168, v120, v121
    v_cvt_pk_bf16_f32 v169, v122, v123
    v_cvt_pk_bf16_f32 v170, v128, v129
    v_cvt_pk_bf16_f32 v171, v130, v131
    v_cvt_pk_bf16_f32 v196, v124, v125
    v_cvt_pk_bf16_f32 v197, v126, v127
    v_cvt_pk_bf16_f32 v198, v132, v133
    v_cvt_pk_bf16_f32 v199, v134, v135
    v_pk_mul_f32 v[120:121], v[136:137], v[12:13] op_sel:[0,0] op_sel_hi:[1,0]
    v_pk_mul_f32 v[128:129], v[144:145], v[12:13] op_sel:[0,0] op_sel_hi:[1,0]
    v_pk_mul_f32 v[122:123], v[138:139], v[12:13] op_sel:[0,0] op_sel_hi:[1,0]
    v_pk_mul_f32 v[130:131], v[146:147], v[12:13] op_sel:[0,0] op_sel_hi:[1,0]
    v_pk_mul_f32 v[124:125], v[140:141], v[12:13] op_sel:[0,0] op_sel_hi:[1,0]
    v_pk_mul_f32 v[132:133], v[148:149], v[12:13] op_sel:[0,0] op_sel_hi:[1,0]
    v_pk_mul_f32 v[126:127], v[142:143], v[12:13] op_sel:[0,0] op_sel_hi:[1,0]
    v_pk_mul_f32 v[134:135], v[150:151], v[12:13] op_sel:[0,0] op_sel_hi:[1,0]
    v_pk_fma_f32 v[120:121], v[144:145], v[12:13], v[120:121] op_sel:[0,1,0] op_sel_hi:[1,1,1]
    v_pk_fma_f32 v[128:129], v[136:137], v[12:13], v[128:129] op_sel:[0,1,0] op_sel_hi:[1,1,1] neg_lo:[0,1,0] neg_hi:[0,1,0]
    v_pk_fma_f32 v[122:123], v[146:147], v[12:13], v[122:123] op_sel:[0,1,0] op_sel_hi:[1,1,1]
    v_pk_fma_f32 v[130:131], v[138:139], v[12:13], v[130:131] op_sel:[0,1,0] op_sel_hi:[1,1,1] neg_lo:[0,1,0] neg_hi:[0,1,0]
    v_pk_fma_f32 v[124:125], v[148:149], v[12:13], v[124:125] op_sel:[0,1,0] op_sel_hi:[1,1,1]
    v_pk_fma_f32 v[132:133], v[140:141], v[12:13], v[132:133] op_sel:[0,1,0] op_sel_hi:[1,1,1] neg_lo:[0,1,0] neg_hi:[0,1,0]
    v_pk_fma_f32 v[126:127], v[150:151], v[12:13], v[126:127] op_sel:[0,1,0] op_sel_hi:[1,1,1]
    v_pk_fma_f32 v[134:135], v[142:143], v[12:13], v[134:135] op_sel:[0,1,0] op_sel_hi:[1,1,1] neg_lo:[0,1,0] neg_hi:[0,1,0]
    v_cvt_pk_bf16_f32 v172, v136, v137
    v_cvt_pk_bf16_f32 v173, v138, v139
    v_cvt_pk_bf16_f32 v174, v144, v145
    v_cvt_pk_bf16_f32 v175, v146, v147
    v_cvt_pk_bf16_f32 v200, v140, v141
    v_cvt_pk_bf16_f32 v201, v142, v143
    v_cvt_pk_bf16_f32 v202, v148, v149
    v_cvt_pk_bf16_f32 v203, v150, v151
    v_pk_mul_f32 v[136:137], v[120:121], v[12:13] op_sel:[0,0] op_sel_hi:[1,0]
    v_pk_mul_f32 v[144:145], v[128:129], v[12:13] op_sel:[0,0] op_sel_hi:[1,0]
    v_pk_mul_f32 v[138:139], v[122:123], v[12:13] op_sel:[0,0] op_sel_hi:[1,0]
    v_pk_mul_f32 v[146:147], v[130:131], v[12:13] op_sel:[0,0] op_sel_hi:[1,0]
    v_pk_mul_f32 v[140:141], v[124:125], v[12:13] op_sel:[0,0] op_sel_hi:[1,0]
    v_pk_mul_f32 v[148:149], v[132:133], v[12:13] op_sel:[0,0] op_sel_hi:[1,0]
    v_pk_mul_f32 v[142:143], v[126:127], v[12:13] op_sel:[0,0] op_sel_hi:[1,0]
    v_pk_mul_f32 v[150:151], v[134:135], v[12:13] op_sel:[0,0] op_sel_hi:[1,0]
    v_pk_fma_f32 v[136:137], v[128:129], v[12:13], v[136:137] op_sel:[0,1,0] op_sel_hi:[1,1,1]
    v_pk_fma_f32 v[144:145], v[120:121], v[12:13], v[144:145] op_sel:[0,1,0] op_sel_hi:[1,1,1] neg_lo:[0,1,0] neg_hi:[0,1,0]
    v_pk_fma_f32 v[138:139], v[130:131], v[12:13], v[138:139] op_sel:[0,1,0] op_sel_hi:[1,1,1]
    v_pk_fma_f32 v[146:147], v[122:123], v[12:13], v[146:147] op_sel:[0,1,0] op_sel_hi:[1,1,1] neg_lo:[0,1,0] neg_hi:[0,1,0]
    v_pk_fma_f32 v[140:141], v[132:133], v[12:13], v[140:141] op_sel:[0,1,0] op_sel_hi:[1,1,1]
    v_pk_fma_f32 v[148:149], v[124:125], v[12:13], v[148:149] op_sel:[0,1,0] op_sel_hi:[1,1,1] neg_lo:[0,1,0] neg_hi:[0,1,0]
    v_pk_fma_f32 v[142:143], v[134:135], v[12:13], v[142:143] op_sel:[0,1,0] op_sel_hi:[1,1,1]
    v_pk_fma_f32 v[150:151], v[126:127], v[12:13], v[150:151] op_sel:[0,1,0] op_sel_hi:[1,1,1] neg_lo:[0,1,0] neg_hi:[0,1,0]
    v_cvt_pk_bf16_f32 v176, v120, v121
    v_cvt_pk_bf16_f32 v177, v122, v123
    v_cvt_pk_bf16_f32 v178, v128, v129
    v_cvt_pk_bf16_f32 v179, v130, v131
    v_cvt_pk_bf16_f32 v204, v124, v125
    v_cvt_pk_bf16_f32 v205, v126, v127
    v_cvt_pk_bf16_f32 v206, v132, v133
    v_cvt_pk_bf16_f32 v207, v134, v135
    v_pk_mul_f32 v[120:121], v[136:137], v[12:13] op_sel:[0,0] op_sel_hi:[1,0]
    v_pk_mul_f32 v[128:129], v[144:145], v[12:13] op_sel:[0,0] op_sel_hi:[1,0]
    v_pk_mul_f32 v[122:123], v[138:139], v[12:13] op_sel:[0,0] op_sel_hi:[1,0]
    v_pk_mul_f32 v[130:131], v[146:147], v[12:13] op_sel:[0,0] op_sel_hi:[1,0]
    v_pk_mul_f32 v[124:125], v[140:141], v[12:13] op_sel:[0,0] op_sel_hi:[1,0]
    v_pk_mul_f32 v[132:133], v[148:149], v[12:13] op_sel:[0,0] op_sel_hi:[1,0]
    v_pk_mul_f32 v[126:127], v[142:143], v[12:13] op_sel:[0,0] op_sel_hi:[1,0]
    v_pk_mul_f32 v[134:135], v[150:151], v[12:13] op_sel:[0,0] op_sel_hi:[1,0]
    v_pk_fma_f32 v[120:121], v[144:145], v[12:13], v[120:121] op_sel:[0,1,0] op_sel_hi:[1,1,1]
    v_pk_fma_f32 v[128:129], v[136:137], v[12:13], v[128:129] op_sel:[0,1,0] op_sel_hi:[1,1,1] neg_lo:[0,1,0] neg_hi:[0,1,0]
    v_pk_fma_f32 v[122:123], v[146:147], v[12:13], v[122:123] op_sel:[0,1,0] op_sel_hi:[1,1,1]
    v_pk_fma_f32 v[130:131], v[138:139], v[12:13], v[130:131] op_sel:[0,1,0] op_sel_hi:[1,1,1] neg_lo:[0,1,0] neg_hi:[0,1,0]
    v_pk_fma_f32 v[124:125], v[148:149], v[12:13], v[124:125] op_sel:[0,1,0] op_sel_hi:[1,1,1]
    v_pk_fma_f32 v[132:133], v[140:141], v[12:13], v[132:133] op_sel:[0,1,0] op_sel_hi:[1,1,1] neg_lo:[0,1,0] neg_hi:[0,1,0]
    v_pk_fma_f32 v[126:127], v[150:151], v[12:13], v[126:127] op_sel:[0,1,0] op_sel_hi:[1,1,1]
    v_pk_fma_f32 v[134:135], v[142:143], v[12:13], v[134:135] op_sel:[0,1,0] op_sel_hi:[1,1,1] neg_lo:[0,1,0] neg_hi:[0,1,0]
    v_cvt_pk_bf16_f32 v180, v136, v137
    v_cvt_pk_bf16_f32 v181, v138, v139
    v_cvt_pk_bf16_f32 v182, v144, v145
    v_cvt_pk_bf16_f32 v183, v146, v147
    v_cvt_pk_bf16_f32 v208, v140, v141
    v_cvt_pk_bf16_f32 v209, v142, v143
    v_cvt_pk_bf16_f32 v210, v148, v149
    v_cvt_pk_bf16_f32 v211, v150, v151
    v_mul_f32 v123, v123, v10
    v_mul_f32 v131, v131, v10
    v_cvt_pk_bf16_f32 v184, v120, v121
    v_cvt_pk_bf16_f32 v185, v122, v123
    v_cvt_pk_bf16_f32 v186, v128, v129
    v_cvt_pk_bf16_f32 v187, v130, v131
    v_cvt_pk_bf16_f32 v212, v124, v125
    v_cvt_pk_bf16_f32 v213, v126, v127
    v_cvt_pk_bf16_f32 v214, v132, v133
    v_cvt_pk_bf16_f32 v215, v134, v135
    s_waitcnt vmcnt(13)
    ds_write_b128 v80, v[16:19]
    s_waitcnt vmcnt(12)
    ds_write_b128 v81, v[20:23]
    s_waitcnt vmcnt(11)
    ds_write_b128 v82, v[24:27]
    s_waitcnt vmcnt(10)
    ds_write_b128 v83, v[28:31]
    s_waitcnt vmcnt(9)
    ds_write_b128 v84, v[32:35]
    s_waitcnt vmcnt(8)
    ds_write_b128 v85, v[36:39]
    s_waitcnt vmcnt(7)
    ds_write_b128 v86, v[40:43]
    s_waitcnt vmcnt(6)
    ds_write_b128 v87, v[44:47]
    s_waitcnt vmcnt(5)
    ds_write_b128 v88, v[48:51]
    s_waitcnt vmcnt(4)
    ds_write_b128 v89, v[52:55]
    s_waitcnt vmcnt(3)
    ds_write_b128 v90, v[56:59]
    s_waitcnt vmcnt(2)
    ds_write_b128 v91, v[60:63]
    s_waitcnt vmcnt(1)
    ds_write_b128 v92, v[64:67]
    s_waitcnt vmcnt(0)
    ds_write_b128 v93, v[68:71]
    s_waitcnt lgkmcnt(0)
    s_barrier
    v_lshrrev_b32 v4, 1, v3
    v_lshlrev_b32 v4, 2, v4
    v_lshrrev_b32 v5, 2, v2
    v_add_u32 v4, v4, v5
    s_lshl_b32 s53, s44, 4
    v_add_u32 v4, s53, v4
    v_mul_u32_u24 v4, 928, v4
    v_and_b32 v5, 1, v3
    v_lshlrev_b32 v5, 4, v5
    v_add_u32 v4, v4, v5
    v_and_b32 v5, 1, v2
    v_lshlrev_b32 v5, 3, v5
    v_add_u32 v4, v4, v5
    v_bfe_u32 v5, v2, 1, 1
    v_mul_u32_u24 v5, 448, v5
    v_add_u32 v4, v4, v5
    v_add_u32 v4, 32768, v4
    v_lshlrev_b32 v5, 4, v1
    s_lshl_b32 s53, s56, 2
    s_add_u32 s53, s53, s44
    s_lshl_b32 s53, s53, 10
    s_add_u32 s53, s53, 0xd00000
    ds_read_b64_tr_b16 v[16:17], v4 offset:0
    ds_read_b64_tr_b16 v[18:19], v4 offset:7424
    ds_read_b64_tr_b16 v[20:21], v4 offset:32
    ds_read_b64_tr_b16 v[22:23], v4 offset:7456
    ds_read_b64_tr_b16 v[24:25], v4 offset:64
    ds_read_b64_tr_b16 v[26:27], v4 offset:7488
    ds_read_b64_tr_b16 v[28:29], v4 offset:96
    ds_read_b64_tr_b16 v[30:31], v4 offset:7520
    ds_read_b64_tr_b16 v[32:33], v4 offset:128
    ds_read_b64_tr_b16 v[34:35], v4 offset:7552
    ds_read_b64_tr_b16 v[36:37], v4 offset:160
    ds_read_b64_tr_b16 v[38:39], v4 offset:7584
    ds_read_b64_tr_b16 v[40:41], v4 offset:192
    ds_read_b64_tr_b16 v[42:43], v4 offset:7616
    ds_read_b64_tr_b16 v[44:45], v4 offset:224
    s_waitcnt lgkmcnt(14)
    ds_read_b64_tr_b16 v[46:47], v4 offset:7648
    s_waitcnt lgkmcnt(14)
    ds_read_b64_tr_b16 v[48:49], v4 offset:256
    s_waitcnt lgkmcnt(14)
    ds_read_b64_tr_b16 v[50:51], v4 offset:7680
    s_waitcnt lgkmcnt(14)
    ds_read_b64_tr_b16 v[52:53], v4 offset:288
    s_waitcnt lgkmcnt(14)
    ds_read_b64_tr_b16 v[54:55], v4 offset:7712
    s_waitcnt lgkmcnt(14)
    ds_read_b64_tr_b16 v[56:57], v4 offset:320
    s_waitcnt lgkmcnt(14)
    ds_read_b64_tr_b16 v[58:59], v4 offset:7744
    s_waitcnt lgkmcnt(14)
    ds_read_b64_tr_b16 v[60:61], v4 offset:352
    s_waitcnt lgkmcnt(14)
    ds_read_b64_tr_b16 v[62:63], v4 offset:7776
    s_waitcnt lgkmcnt(14)
    ds_read_b64_tr_b16 v[92:93], v4 offset:384
    s_waitcnt lgkmcnt(14)
    ds_read_b64_tr_b16 v[94:95], v4 offset:7808
    s_waitcnt lgkmcnt(14)
    ds_read_b64_tr_b16 v[96:97], v4 offset:416
    s_waitcnt lgkmcnt(14)
    ds_read_b64_tr_b16 v[98:99], v4 offset:7840
    s_waitcnt lgkmcnt(0)
    s_mov_b32 s99, s53
    s_branch Lp2done_20
Lp2none_21:
    s_lshl_b32 s61, s46, 2
    s_add_u32 s61, s61, s44
    s_min_u32 s61, s61, 13
    s_lshl_b32 s61, s61, 4
    v_add_u32 v8, s61, v2
    v_cvt_f32_u32 v8, v8
    v_mul_f32 v8, 0x3b124925, v8
    v_lshlrev_b32 v9, 3, v3
    v_cvt_f32_u32 v9, v9
    v_mul_f32 v9, v9, v8
    v_cmp_eq_u32 vcc, 3, v3
    v_mov_b32 v10, 1.0
    v_mov_b32 v7, 0.5
    v_cndmask_b32 v10, v10, v7, vcc
    v_mul_f32 v7, 0x42000000, v8
    v_fmamk_f32 v112, v8, 0x40000000, v9
    v_fmamk_f32 v113, v8, 0x40800000, v9
    v_fmamk_f32 v114, v8, 0x40c00000, v9
    v_fmamk_f32 v115, v8, 0x41000000, v9
    v_fmamk_f32 v116, v8, 0x3f800000, v9
    v_fmamk_f32 v117, v8, 0x40400000, v9
    v_fmamk_f32 v118, v8, 0x40a00000, v9
    v_fmamk_f32 v119, v8, 0x40e00000, v9
    v_cos_f32 v12, v7
    v_sin_f32 v13, v7
    v_cos_f32 v120, v112
    v_cos_f32 v121, v113
    v_cos_f32 v122, v114
    v_cos_f32 v123, v115
    v_cos_f32 v124, v116
    v_cos_f32 v125, v117
    v_cos_f32 v126, v118
    v_cos_f32 v127, v119
    v_sin_f32_e64 v128, -v112
    v_sin_f32_e64 v129, -v113
    v_sin_f32_e64 v130, -v114
    v_sin_f32_e64 v131, -v115
    v_sin_f32_e64 v132, -v116
    v_sin_f32_e64 v133, -v117
    v_sin_f32_e64 v134, -v118
    v_sin_f32_e64 v135, -v119
    v_pk_mul_f32 v[136:137], v[120:121], v[12:13] op_sel:[0,0] op_sel_hi:[1,0]
    v_pk_mul_f32 v[144:145], v[128:129], v[12:13] op_sel:[0,0] op_sel_hi:[1,0]
    v_pk_mul_f32 v[138:139], v[122:123], v[12:13] op_sel:[0,0] op_sel_hi:[1,0]
    v_pk_mul_f32 v[146:147], v[130:131], v[12:13] op_sel:[0,0] op_sel_hi:[1,0]
    v_pk_mul_f32 v[140:141], v[124:125], v[12:13] op_sel:[0,0] op_sel_hi:[1,0]
    v_pk_mul_f32 v[148:149], v[132:133], v[12:13] op_sel:[0,0] op_sel_hi:[1,0]
    v_pk_mul_f32 v[142:143], v[126:127], v[12:13] op_sel:[0,0] op_sel_hi:[1,0]
    v_pk_mul_f32 v[150:151], v[134:135], v[12:13] op_sel:[0,0] op_sel_hi:[1,0]
    v_pk_fma_f32 v[136:137], v[128:129], v[12:13], v[136:137] op_sel:[0,1,0] op_sel_hi:[1,1,1]
    v_pk_fma_f32 v[144:145], v[120:121], v[12:13], v[144:145] op_sel:[0,1,0] op_sel_hi:[1,1,1] neg_lo:[0,1,0] neg_hi:[0,1,0]
    v_pk_fma_f32 v[138:139], v[130:131], v[12:13], v[138:139] op_sel:[0,1,0] op_sel_hi:[1,1,1]
    v_pk_fma_f32 v[146:147], v[122:123], v[12:13], v[146:147] op_sel:[0,1,0] op_sel_hi:[1,1,1] neg_lo:[0,1,0] neg_hi:[0,1,0]
    v_pk_fma_f32 v[140:141], v[132:133], v[12:13], v[140:141] op_sel:[0,1,0] op_sel_hi:[1,1,1]
    v_pk_fma_f32 v[148:149], v[124:125], v[12:13], v[148:149] op_sel:[0,1,0] op_sel_hi:[1,1,1] neg_lo:[0,1,0] neg_hi:[0,1,0]
    v_pk_fma_f32 v[142:143], v[134:135], v[12:13], v[142:143] op_sel:[0,1,0] op_sel_hi:[1,1,1]
    v_pk_fma_f32 v[150:151], v[126:127], v[12:13], v[150:151] op_sel:[0,1,0] op_sel_hi:[1,1,1] neg_lo:[0,1,0] neg_hi:[0,1,0]
    v_cvt_pk_bf16_f32 v160, v120, v121
    v_cvt_pk_bf16_f32 v161, v122, v123
    v_cvt_pk_bf16_f32 v162, v128, v129
    v_cvt_pk_bf16_f32 v163, v130, v131
    v_cvt_pk_bf16_f32 v188, v124, v125
    v_cvt_pk_bf16_f32 v189, v126, v127
    v_cvt_pk_bf16_f32 v190, v132, v133
    v_cvt_pk_bf16_f32 v191, v134, v135
    v_pk_mul_f32 v[120:121], v[136:137], v[12:13] op_sel:[0,0] op_sel_hi:[1,0]
    v_pk_mul_f32 v[128:129], v[144:145], v[12:13] op_sel:[0,0] op_sel_hi:[1,0]
    v_pk_mul_f32 v[122:123], v[138:139], v[12:13] op_sel:[0,0] op_sel_hi:[1,0]
    v_pk_mul_f32 v[130:131], v[146:147], v[12:13] op_sel:[0,0] op_sel_hi:[1,0]
    v_pk_mul_f32 v[124:125], v[140:141], v[12:13] op_sel:[0,0] op_sel_hi:[1,0]
    v_pk_mul_f32 v[132:133], v[148:149], v[12:13] op_sel:[0,0] op_sel_hi:[1,0]
    v_pk_mul_f32 v[126:127], v[142:143], v[12:13] op_sel:[0,0] op_sel_hi:[1,0]
    v_pk_mul_f32 v[134:135], v[150:151], v[12:13] op_sel:[0,0] op_sel_hi:[1,0]
    v_pk_fma_f32 v[120:121], v[144:145], v[12:13], v[120:121] op_sel:[0,1,0] op_sel_hi:[1,1,1]
    v_pk_fma_f32 v[128:129], v[136:137], v[12:13], v[128:129] op_sel:[0,1,0] op_sel_hi:[1,1,1] neg_lo:[0,1,0] neg_hi:[0,1,0]
    v_pk_fma_f32 v[122:123], v[146:147], v[12:13], v[122:123] op_sel:[0,1,0] op_sel_hi:[1,1,1]
    v_pk_fma_f32 v[130:131], v[138:139], v[12:13], v[130:131] op_sel:[0,1,0] op_sel_hi:[1,1,1] neg_lo:[0,1,0] neg_hi:[0,1,0]
    v_pk_fma_f32 v[124:125], v[148:149], v[12:13], v[124:125] op_sel:[0,1,0] op_sel_hi:[1,1,1]
    v_pk_fma_f32 v[132:133], v[140:141], v[12:13], v[132:133] op_sel:[0,1,0] op_sel_hi:[1,1,1] neg_lo:[0,1,0] neg_hi:[0,1,0]
    v_pk_fma_f32 v[126:127], v[150:151], v[12:13], v[126:127] op_sel:[0,1,0] op_sel_hi:[1,1,1]
    v_pk_fma_f32 v[134:135], v[142:143], v[12:13], v[134:135] op_sel:[0,1,0] op_sel_hi:[1,1,1] neg_lo:[0,1,0] neg_hi:[0,1,0]
    v_cvt_pk_bf16_f32 v164, v136, v137
    v_cvt_pk_bf16_f32 v165, v138, v139
    v_cvt_pk_bf16_f32 v166, v144, v145
    v_cvt_pk_bf16_f32 v167, v146, v147
    v_cvt_pk_bf16_f32 v192, v140, v141
    v_cvt_pk_bf16_f32 v193, v142, v143
    v_cvt_pk_bf16_f32 v194, v148, v149
    v_cvt_pk_bf16_f32 v195, v150, v151
    v_pk_mul_f32 v[136:137], v[120:121], v[12:13] op_sel:[0,0] op_sel_hi:[1,0]
    v_pk_mul_f32 v[144:145], v[128:129], v[12:13] op_sel:[0,0] op_sel_hi:[1,0]
    v_pk_mul_f32 v[138:139], v[122:123], v[12:13] op_sel:[0,0] op_sel_hi:[1,0]
    v_pk_mul_f32 v[146:147], v[130:131], v[12:13] op_sel:[0,0] op_sel_hi:[1,0]
    v_pk_mul_f32 v[140:141], v[124:125], v[12:13] op_sel:[0,0] op_sel_hi:[1,0]
    v_pk_mul_f32 v[148:149], v[132:133], v[12:13] op_sel:[0,0] op_sel_hi:[1,0]
    v_pk_mul_f32 v[142:143], v[126:127], v[12:13] op_sel:[0,0] op_sel_hi:[1,0]
    v_pk_mul_f32 v[150:151], v[134:135], v[12:13] op_sel:[0,0] op_sel_hi:[1,0]
    v_pk_fma_f32 v[136:137], v[128:129], v[12:13], v[136:137] op_sel:[0,1,0] op_sel_hi:[1,1,1]
    v_pk_fma_f32 v[144:145], v[120:121], v[12:13], v[144:145] op_sel:[0,1,0] op_sel_hi:[1,1,1] neg_lo:[0,1,0] neg_hi:[0,1,0]
    v_pk_fma_f32 v[138:139], v[130:131], v[12:13], v[138:139] op_sel:[0,1,0] op_sel_hi:[1,1,1]
    v_pk_fma_f32 v[146:147], v[122:123], v[12:13], v[146:147] op_sel:[0,1,0] op_sel_hi:[1,1,1] neg_lo:[0,1,0] neg_hi:[0,1,0]
    v_pk_fma_f32 v[140:141], v[132:133], v[12:13], v[140:141] op_sel:[0,1,0] op_sel_hi:[1,1,1]
    v_pk_fma_f32 v[148:149], v[124:125], v[12:13], v[148:149] op_sel:[0,1,0] op_sel_hi:[1,1,1] neg_lo:[0,1,0] neg_hi:[0,1,0]
    v_pk_fma_f32 v[142:143], v[134:135], v[12:13], v[142:143] op_sel:[0,1,0] op_sel_hi:[1,1,1]
    v_pk_fma_f32 v[150:151], v[126:127], v[12:13], v[150:151] op_sel:[0,1,0] op_sel_hi:[1,1,1] neg_lo:[0,1,0] neg_hi:[0,1,0]
    v_cvt_pk_bf16_f32 v168, v120, v121
    v_cvt_pk_bf16_f32 v169, v122, v123
    v_cvt_pk_bf16_f32 v170, v128, v129
    v_cvt_pk_bf16_f32 v171, v130, v131
    v_cvt_pk_bf16_f32 v196, v124, v125
    v_cvt_pk_bf16_f32 v197, v126, v127
    v_cvt_pk_bf16_f32 v198, v132, v133
    v_cvt_pk_bf16_f32 v199, v134, v135
    v_pk_mul_f32 v[120:121], v[136:137], v[12:13] op_sel:[0,0] op_sel_hi:[1,0]
    v_pk_mul_f32 v[128:129], v[144:145], v[12:13] op_sel:[0,0] op_sel_hi:[1,0]
    v_pk_mul_f32 v[122:123], v[138:139], v[12:13] op_sel:[0,0] op_sel_hi:[1,0]
    v_pk_mul_f32 v[130:131], v[146:147], v[12:13] op_sel:[0,0] op_sel_hi:[1,0]
    v_pk_mul_f32 v[124:125], v[140:141], v[12:13] op_sel:[0,0] op_sel_hi:[1,0]
    v_pk_mul_f32 v[132:133], v[148:149], v[12:13] op_sel:[0,0] op_sel_hi:[1,0]
    v_pk_mul_f32 v[126:127], v[142:143], v[12:13] op_sel:[0,0] op_sel_hi:[1,0]
    v_pk_mul_f32 v[134:135], v[150:151], v[12:13] op_sel:[0,0] op_sel_hi:[1,0]
    v_pk_fma_f32 v[120:121], v[144:145], v[12:13], v[120:121] op_sel:[0,1,0] op_sel_hi:[1,1,1]
    v_pk_fma_f32 v[128:129], v[136:137], v[12:13], v[128:129] op_sel:[0,1,0] op_sel_hi:[1,1,1] neg_lo:[0,1,0] neg_hi:[0,1,0]
    v_pk_fma_f32 v[122:123], v[146:147], v[12:13], v[122:123] op_sel:[0,1,0] op_sel_hi:[1,1,1]
    v_pk_fma_f32 v[130:131], v[138:139], v[12:13], v[130:131] op_sel:[0,1,0] op_sel_hi:[1,1,1] neg_lo:[0,1,0] neg_hi:[0,1,0]
    v_pk_fma_f32 v[124:125], v[148:149], v[12:13], v[124:125] op_sel:[0,1,0] op_sel_hi:[1,1,1]
    v_pk_fma_f32 v[132:133], v[140:141], v[12:13], v[132:133] op_sel:[0,1,0] op_sel_hi:[1,1,1] neg_lo:[0,1,0] neg_hi:[0,1,0]
    v_pk_fma_f32 v[126:127], v[150:151], v[12:13], v[126:127] op_sel:[0,1,0] op_sel_hi:[1,1,1]
    v_pk_fma_f32 v[134:135], v[142:143], v[12:13], v[134:135] op_sel:[0,1,0] op_sel_hi:[1,1,1] neg_lo:[0,1,0] neg_hi:[0,1,0]
    v_cvt_pk_bf16_f32 v172, v136, v137
    v_cvt_pk_bf16_f32 v173, v138, v139
    v_cvt_pk_bf16_f32 v174, v144, v145
    v_cvt_pk_bf16_f32 v175, v146, v147
    v_cvt_pk_bf16_f32 v200, v140, v141
    v_cvt_pk_bf16_f32 v201, v142, v143
    v_cvt_pk_bf16_f32 v202, v148, v149
    v_cvt_pk_bf16_f32 v203, v150, v151
    v_pk_mul_f32 v[136:137], v[120:121], v[12:13] op_sel:[0,0] op_sel_hi:[1,0]
    v_pk_mul_f32 v[144:145], v[128:129], v[12:13] op_sel:[0,0] op_sel_hi:[1,0]
    v_pk_mul_f32 v[138:139], v[122:123], v[12:13] op_sel:[0,0] op_sel_hi:[1,0]
    v_pk_mul_f32 v[146:147], v[130:131], v[12:13] op_sel:[0,0] op_sel_hi:[1,0]
    v_pk_mul_f32 v[140:141], v[124:125], v[12:13] op_sel:[0,0] op_sel_hi:[1,0]
    v_pk_mul_f32 v[148:149], v[132:133], v[12:13] op_sel:[0,0] op_sel_hi:[1,0]
    v_pk_mul_f32 v[142:143], v[126:127], v[12:13] op_sel:[0,0] op_sel_hi:[1,0]
    v_pk_mul_f32 v[150:151], v[134:135], v[12:13] op_sel:[0,0] op_sel_hi:[1,0]
    v_pk_fma_f32 v[136:137], v[128:129], v[12:13], v[136:137] op_sel:[0,1,0] op_sel_hi:[1,1,1]
    v_pk_fma_f32 v[144:145], v[120:121], v[12:13], v[144:145] op_sel:[0,1,0] op_sel_hi:[1,1,1] neg_lo:[0,1,0] neg_hi:[0,1,0]
    v_pk_fma_f32 v[138:139], v[130:131], v[12:13], v[138:139] op_sel:[0,1,0] op_sel_hi:[1,1,1]
    v_pk_fma_f32 v[146:147], v[122:123], v[12:13], v[146:147] op_sel:[0,1,0] op_sel_hi:[1,1,1] neg_lo:[0,1,0] neg_hi:[0,1,0]
    v_pk_fma_f32 v[140:141], v[132:133], v[12:13], v[140:141] op_sel:[0,1,0] op_sel_hi:[1,1,1]
    v_pk_fma_f32 v[148:149], v[124:125], v[12:13], v[148:149] op_sel:[0,1,0] op_sel_hi:[1,1,1] neg_lo:[0,1,0] neg_hi:[0,1,0]
    v_pk_fma_f32 v[142:143], v[134:135], v[12:13], v[142:143] op_sel:[0,1,0] op_sel_hi:[1,1,1]
    v_pk_fma_f32 v[150:151], v[126:127], v[12:13], v[150:151] op_sel:[0,1,0] op_sel_hi:[1,1,1] neg_lo:[0,1,0] neg_hi:[0,1,0]
    v_cvt_pk_bf16_f32 v176, v120, v121
    v_cvt_pk_bf16_f32 v177, v122, v123
    v_cvt_pk_bf16_f32 v178, v128, v129
    v_cvt_pk_bf16_f32 v179, v130, v131
    v_cvt_pk_bf16_f32 v204, v124, v125
    v_cvt_pk_bf16_f32 v205, v126, v127
    v_cvt_pk_bf16_f32 v206, v132, v133
    v_cvt_pk_bf16_f32 v207, v134, v135
    v_pk_mul_f32 v[120:121], v[136:137], v[12:13] op_sel:[0,0] op_sel_hi:[1,0]
    v_pk_mul_f32 v[128:129], v[144:145], v[12:13] op_sel:[0,0] op_sel_hi:[1,0]
    v_pk_mul_f32 v[122:123], v[138:139], v[12:13] op_sel:[0,0] op_sel_hi:[1,0]
    v_pk_mul_f32 v[130:131], v[146:147], v[12:13] op_sel:[0,0] op_sel_hi:[1,0]
    v_pk_mul_f32 v[124:125], v[140:141], v[12:13] op_sel:[0,0] op_sel_hi:[1,0]
    v_pk_mul_f32 v[132:133], v[148:149], v[12:13] op_sel:[0,0] op_sel_hi:[1,0]
    v_pk_mul_f32 v[126:127], v[142:143], v[12:13] op_sel:[0,0] op_sel_hi:[1,0]
    v_pk_mul_f32 v[134:135], v[150:151], v[12:13] op_sel:[0,0] op_sel_hi:[1,0]
    v_pk_fma_f32 v[120:121], v[144:145], v[12:13], v[120:121] op_sel:[0,1,0] op_sel_hi:[1,1,1]
    v_pk_fma_f32 v[128:129], v[136:137], v[12:13], v[128:129] op_sel:[0,1,0] op_sel_hi:[1,1,1] neg_lo:[0,1,0] neg_hi:[0,1,0]
    v_pk_fma_f32 v[122:123], v[146:147], v[12:13], v[122:123] op_sel:[0,1,0] op_sel_hi:[1,1,1]
    v_pk_fma_f32 v[130:131], v[138:139], v[12:13], v[130:131] op_sel:[0,1,0] op_sel_hi:[1,1,1] neg_lo:[0,1,0] neg_hi:[0,1,0]
    v_pk_fma_f32 v[124:125], v[148:149], v[12:13], v[124:125] op_sel:[0,1,0] op_sel_hi:[1,1,1]
    v_pk_fma_f32 v[132:133], v[140:141], v[12:13], v[132:133] op_sel:[0,1,0] op_sel_hi:[1,1,1] neg_lo:[0,1,0] neg_hi:[0,1,0]
    v_pk_fma_f32 v[126:127], v[150:151], v[12:13], v[126:127] op_sel:[0,1,0] op_sel_hi:[1,1,1]
    v_pk_fma_f32 v[134:135], v[142:143], v[12:13], v[134:135] op_sel:[0,1,0] op_sel_hi:[1,1,1] neg_lo:[0,1,0] neg_hi:[0,1,0]
    v_cvt_pk_bf16_f32 v180, v136, v137
    v_cvt_pk_bf16_f32 v181, v138, v139
    v_cvt_pk_bf16_f32 v182, v144, v145
    v_cvt_pk_bf16_f32 v183, v146, v147
    v_cvt_pk_bf16_f32 v208, v140, v141
    v_cvt_pk_bf16_f32 v209, v142, v143
    v_cvt_pk_bf16_f32 v210, v148, v149
    v_cvt_pk_bf16_f32 v211, v150, v151
    v_mul_f32 v123, v123, v10
    v_mul_f32 v131, v131, v10
    v_cvt_pk_bf16_f32 v184, v120, v121
    v_cvt_pk_bf16_f32 v185, v122, v123
    v_cvt_pk_bf16_f32 v186, v128, v129
    v_cvt_pk_bf16_f32 v187, v130, v131
    v_cvt_pk_bf16_f32 v212, v124, v125
    v_cvt_pk_bf16_f32 v213, v126, v127
    v_cvt_pk_bf16_f32 v214, v132, v133
    v_cvt_pk_bf16_f32 v215, v134, v135
    v_cvt_f32_u32 v7, v3
    v_add_u32 v8, 0, v2
    v_lshlrev_b32 v8, 6, v8
    v_add_u32 v8, s45, v8
    v_cvt_f32_u32 v8, v8
    v_mul_f32 v8, 0x3a000000, v8
    v_mul_f32 v9, v7, v8
    v_mov_b32 v112, v9
    v_fmamk_f32 v113, v8, 0x40800000, v9
    v_fmamk_f32 v114, v8, 0x41000000, v9
    v_fmamk_f32 v115, v8, 0x41400000, v9
    v_fmamk_f32 v116, v8, 0x41800000, v9
    v_fmamk_f32 v117, v8, 0x41a00000, v9
    v_fmamk_f32 v118, v8, 0x41c00000, v9
    v_fmamk_f32 v119, v8, 0x41e00000, v9
    v_cos_f32 v120, v112
    v_cos_f32 v121, v113
    v_cos_f32 v122, v114
    v_cos_f32 v123, v115
    v_cos_f32 v124, v116
    v_cos_f32 v125, v117
    v_cos_f32 v126, v118
    v_cos_f32 v127, v119
    v_sin_f32 v128, v112
    v_sin_f32 v129, v113
    v_sin_f32 v130, v114
    v_sin_f32 v131, v115
    v_sin_f32 v132, v116
    v_sin_f32 v133, v117
    v_sin_f32 v134, v118
    v_sin_f32 v135, v119
    v_mul_f32 v120, 0x36124925, v120
    v_mul_f32 v121, 0x36124925, v121
    v_mul_f32 v122, 0x36124925, v122
    v_mul_f32 v123, 0x36124925, v123
    v_mul_f32 v124, 0x36124925, v124
    v_mul_f32 v125, 0x36124925, v125
    v_mul_f32 v126, 0x36124925, v126
    v_mul_f32 v127, 0x36124925, v127
    v_mul_f32 v128, 0x36124925, v128
    v_mul_f32 v129, 0x36124925, v129
    v_mul_f32 v130, 0x36124925, v130
    v_mul_f32 v131, 0x36124925, v131
    v_mul_f32 v132, 0x36124925, v132
    v_mul_f32 v133, 0x36124925, v133
    v_mul_f32 v134, 0x36124925, v134
    v_mul_f32 v135, 0x36124925, v135
    v_cvt_pk_bf16_f32 v220, v120, -v128
    v_cvt_pk_bf16_f32 v236, v128, v120
    v_cvt_pk_bf16_f32 v221, v121, -v129
    v_cvt_pk_bf16_f32 v237, v129, v121
    v_cvt_pk_bf16_f32 v222, v122, -v130
    v_cvt_pk_bf16_f32 v238, v130, v122
    v_cvt_pk_bf16_f32 v223, v123, -v131
    v_cvt_pk_bf16_f32 v239, v131, v123
    v_cvt_pk_bf16_f32 v228, v124, -v132
    v_cvt_pk_bf16_f32 v244, v132, v124
    v_cvt_pk_bf16_f32 v229, v125, -v133
    v_cvt_pk_bf16_f32 v245, v133, v125
    v_cvt_pk_bf16_f32 v230, v126, -v134
    v_cvt_pk_bf16_f32 v246, v134, v126
    v_cvt_pk_bf16_f32 v231, v127, -v135
    v_cvt_pk_bf16_f32 v247, v135, v127
    v_add_u32 v8, 16, v2
    v_lshlrev_b32 v8, 6, v8
    v_add_u32 v8, s45, v8
    v_cvt_f32_u32 v8, v8
    v_mul_f32 v8, 0x3a000000, v8
    v_mul_f32 v9, v7, v8
    v_mov_b32 v112, v9
    v_fmamk_f32 v113, v8, 0x40800000, v9
    v_fmamk_f32 v114, v8, 0x41000000, v9
    v_fmamk_f32 v115, v8, 0x41400000, v9
    v_fmamk_f32 v116, v8, 0x41800000, v9
    v_fmamk_f32 v117, v8, 0x41a00000, v9
    v_fmamk_f32 v118, v8, 0x41c00000, v9
    v_fmamk_f32 v119, v8, 0x41e00000, v9
    v_cos_f32 v120, v112
    v_cos_f32 v121, v113
    v_cos_f32 v122, v114
    v_cos_f32 v123, v115
    v_cos_f32 v124, v116
    v_cos_f32 v125, v117
    v_cos_f32 v126, v118
    v_cos_f32 v127, v119
    v_sin_f32 v128, v112
    v_sin_f32 v129, v113
    v_sin_f32 v130, v114
    v_sin_f32 v131, v115
    v_sin_f32 v132, v116
    v_sin_f32 v133, v117
    v_sin_f32 v134, v118
    v_sin_f32 v135, v119
    v_mul_f32 v120, 0x36124925, v120
    v_mul_f32 v121, 0x36124925, v121
    v_mul_f32 v122, 0x36124925, v122
    v_mul_f32 v123, 0x36124925, v123
    v_mul_f32 v124, 0x36124925, v124
    v_mul_f32 v125, 0x36124925, v125
    v_mul_f32 v126, 0x36124925, v126
    v_mul_f32 v127, 0x36124925, v127
    v_mul_f32 v128, 0x36124925, v128
    v_mul_f32 v129, 0x36124925, v129
    v_mul_f32 v130, 0x36124925, v130
    v_mul_f32 v131, 0x36124925, v131
    v_mul_f32 v132, 0x36124925, v132
    v_mul_f32 v133, 0x36124925, v133
    v_mul_f32 v134, 0x36124925, v134
    v_mul_f32 v135, 0x36124925, v135
    v_cvt_pk_bf16_f32 v224, v120, -v128
    v_cvt_pk_bf16_f32 v240, v128, v120
    v_cvt_pk_bf16_f32 v225, v121, -v129
    v_cvt_pk_bf16_f32 v241, v129, v121
    v_cvt_pk_bf16_f32 v226, v122, -v130
    v_cvt_pk_bf16_f32 v242, v130, v122
    v_cvt_pk_bf16_f32 v227, v123, -v131
    v_cvt_pk_bf16_f32 v243, v131, v123
    v_cvt_pk_bf16_f32 v232, v124, -v132
    v_cvt_pk_bf16_f32 v248, v132, v124
    v_cvt_pk_bf16_f32 v233, v125, -v133
    v_cvt_pk_bf16_f32 v249, v133, v125
    v_cvt_pk_bf16_f32 v234, v126, -v134
    v_cvt_pk_bf16_f32 v250, v134, v126
    v_cvt_pk_bf16_f32 v235, v127, -v135
    v_cvt_pk_bf16_f32 v251, v135, v127
Lp2done_20:
    s_waitcnt vmcnt(0)
    s_branch Ljoin_12
Ljoin_11:
    s_barrier
    s_cmp_lg_u32 s44, 0
    s_cbranch_scc1 Lsig_22
    s_lshl_b32 s52, s2, 6
    s_add_u32 s52, s52, 0x1840000
    v_mov_b32 v14, s47
    v_lshlrev_b32 v15, 14, v1
    s_mov_b64 exec, 0xff
    buffer_store_dword v14, v15, s[12:15], s52 offen sc1
    s_mov_b64 exec, -1
Lsig_22:
    s_lshl_b32 s61, s46, 2
    s_add_u32 s61, s61, s44
    s_min_u32 s61, s61, 13
    s_lshl_b32 s61, s61, 4
    v_add_u32 v8, s61, v2
    v_cvt_f32_u32 v8, v8
    v_mul_f32 v8, 0x3b124925, v8
    v_lshlrev_b32 v9, 3, v3
    v_cvt_f32_u32 v9, v9
    v_mul_f32 v9, v9, v8
    v_cmp_eq_u32 vcc, 3, v3
    v_mov_b32 v10, 1.0
    v_mov_b32 v7, 0.5
    v_cndmask_b32 v10, v10, v7, vcc
    v_mul_f32 v7, 0x42000000, v8
    v_fmamk_f32 v112, v8, 0x40000000, v9
    v_fmamk_f32 v113, v8, 0x40800000, v9
    v_fmamk_f32 v114, v8, 0x40c00000, v9
    v_fmamk_f32 v115, v8, 0x41000000, v9
    v_fmamk_f32 v116, v8, 0x3f800000, v9
    v_fmamk_f32 v117, v8, 0x40400000, v9
    v_fmamk_f32 v118, v8, 0x40a00000, v9
    v_fmamk_f32 v119, v8, 0x40e00000, v9
    v_cos_f32 v12, v7
    v_sin_f32 v13, v7
    v_cos_f32 v120, v112
    v_cos_f32 v121, v113
    v_cos_f32 v122, v114
    v_cos_f32 v123, v115
    v_cos_f32 v124, v116
    v_cos_f32 v125, v117
    v_cos_f32 v126, v118
    v_cos_f32 v127, v119
    v_sin_f32_e64 v128, -v112
    v_sin_f32_e64 v129, -v113
    v_sin_f32_e64 v130, -v114
    v_sin_f32_e64 v131, -v115
    v_sin_f32_e64 v132, -v116
    v_sin_f32_e64 v133, -v117
    v_sin_f32_e64 v134, -v118
    v_sin_f32_e64 v135, -v119
    v_pk_mul_f32 v[136:137], v[120:121], v[12:13] op_sel:[0,0] op_sel_hi:[1,0]
    v_pk_mul_f32 v[144:145], v[128:129], v[12:13] op_sel:[0,0] op_sel_hi:[1,0]
    v_pk_mul_f32 v[138:139], v[122:123], v[12:13] op_sel:[0,0] op_sel_hi:[1,0]
    v_pk_mul_f32 v[146:147], v[130:131], v[12:13] op_sel:[0,0] op_sel_hi:[1,0]
    v_pk_mul_f32 v[140:141], v[124:125], v[12:13] op_sel:[0,0] op_sel_hi:[1,0]
    v_pk_mul_f32 v[148:149], v[132:133], v[12:13] op_sel:[0,0] op_sel_hi:[1,0]
    v_pk_mul_f32 v[142:143], v[126:127], v[12:13] op_sel:[0,0] op_sel_hi:[1,0]
    v_pk_mul_f32 v[150:151], v[134:135], v[12:13] op_sel:[0,0] op_sel_hi:[1,0]
    v_pk_fma_f32 v[136:137], v[128:129], v[12:13], v[136:137] op_sel:[0,1,0] op_sel_hi:[1,1,1]
    v_pk_fma_f32 v[144:145], v[120:121], v[12:13], v[144:145] op_sel:[0,1,0] op_sel_hi:[1,1,1] neg_lo:[0,1,0] neg_hi:[0,1,0]
    v_pk_fma_f32 v[138:139], v[130:131], v[12:13], v[138:139] op_sel:[0,1,0] op_sel_hi:[1,1,1]
    v_pk_fma_f32 v[146:147], v[122:123], v[12:13], v[146:147] op_sel:[0,1,0] op_sel_hi:[1,1,1] neg_lo:[0,1,0] neg_hi:[0,1,0]
    v_pk_fma_f32 v[140:141], v[132:133], v[12:13], v[140:141] op_sel:[0,1,0] op_sel_hi:[1,1,1]
    v_pk_fma_f32 v[148:149], v[124:125], v[12:13], v[148:149] op_sel:[0,1,0] op_sel_hi:[1,1,1] neg_lo:[0,1,0] neg_hi:[0,1,0]
    v_pk_fma_f32 v[142:143], v[134:135], v[12:13], v[142:143] op_sel:[0,1,0] op_sel_hi:[1,1,1]
    v_pk_fma_f32 v[150:151], v[126:127], v[12:13], v[150:151] op_sel:[0,1,0] op_sel_hi:[1,1,1] neg_lo:[0,1,0] neg_hi:[0,1,0]
    v_cvt_pk_bf16_f32 v160, v120, v121
    v_cvt_pk_bf16_f32 v161, v122, v123
    v_cvt_pk_bf16_f32 v162, v128, v129
    v_cvt_pk_bf16_f32 v163, v130, v131
    v_cvt_pk_bf16_f32 v188, v124, v125
    v_cvt_pk_bf16_f32 v189, v126, v127
    v_cvt_pk_bf16_f32 v190, v132, v133
    v_cvt_pk_bf16_f32 v191, v134, v135
    v_pk_mul_f32 v[120:121], v[136:137], v[12:13] op_sel:[0,0] op_sel_hi:[1,0]
    v_pk_mul_f32 v[128:129], v[144:145], v[12:13] op_sel:[0,0] op_sel_hi:[1,0]
    v_pk_mul_f32 v[122:123], v[138:139], v[12:13] op_sel:[0,0] op_sel_hi:[1,0]
    v_pk_mul_f32 v[130:131], v[146:147], v[12:13] op_sel:[0,0] op_sel_hi:[1,0]
    v_pk_mul_f32 v[124:125], v[140:141], v[12:13] op_sel:[0,0] op_sel_hi:[1,0]
    v_pk_mul_f32 v[132:133], v[148:149], v[12:13] op_sel:[0,0] op_sel_hi:[1,0]
    v_pk_mul_f32 v[126:127], v[142:143], v[12:13] op_sel:[0,0] op_sel_hi:[1,0]
    v_pk_mul_f32 v[134:135], v[150:151], v[12:13] op_sel:[0,0] op_sel_hi:[1,0]
    v_pk_fma_f32 v[120:121], v[144:145], v[12:13], v[120:121] op_sel:[0,1,0] op_sel_hi:[1,1,1]
    v_pk_fma_f32 v[128:129], v[136:137], v[12:13], v[128:129] op_sel:[0,1,0] op_sel_hi:[1,1,1] neg_lo:[0,1,0] neg_hi:[0,1,0]
    v_pk_fma_f32 v[122:123], v[146:147], v[12:13], v[122:123] op_sel:[0,1,0] op_sel_hi:[1,1,1]
    v_pk_fma_f32 v[130:131], v[138:139], v[12:13], v[130:131] op_sel:[0,1,0] op_sel_hi:[1,1,1] neg_lo:[0,1,0] neg_hi:[0,1,0]
    v_pk_fma_f32 v[124:125], v[148:149], v[12:13], v[124:125] op_sel:[0,1,0] op_sel_hi:[1,1,1]
    v_pk_fma_f32 v[132:133], v[140:141], v[12:13], v[132:133] op_sel:[0,1,0] op_sel_hi:[1,1,1] neg_lo:[0,1,0] neg_hi:[0,1,0]
    v_pk_fma_f32 v[126:127], v[150:151], v[12:13], v[126:127] op_sel:[0,1,0] op_sel_hi:[1,1,1]
    v_pk_fma_f32 v[134:135], v[142:143], v[12:13], v[134:135] op_sel:[0,1,0] op_sel_hi:[1,1,1] neg_lo:[0,1,0] neg_hi:[0,1,0]
    v_cvt_pk_bf16_f32 v164, v136, v137
    v_cvt_pk_bf16_f32 v165, v138, v139
    v_cvt_pk_bf16_f32 v166, v144, v145
    v_cvt_pk_bf16_f32 v167, v146, v147
    v_cvt_pk_bf16_f32 v192, v140, v141
    v_cvt_pk_bf16_f32 v193, v142, v143
    v_cvt_pk_bf16_f32 v194, v148, v149
    v_cvt_pk_bf16_f32 v195, v150, v151
    v_pk_mul_f32 v[136:137], v[120:121], v[12:13] op_sel:[0,0] op_sel_hi:[1,0]
    v_pk_mul_f32 v[144:145], v[128:129], v[12:13] op_sel:[0,0] op_sel_hi:[1,0]
    v_pk_mul_f32 v[138:139], v[122:123], v[12:13] op_sel:[0,0] op_sel_hi:[1,0]
    v_pk_mul_f32 v[146:147], v[130:131], v[12:13] op_sel:[0,0] op_sel_hi:[1,0]
    v_pk_mul_f32 v[140:141], v[124:125], v[12:13] op_sel:[0,0] op_sel_hi:[1,0]
    v_pk_mul_f32 v[148:149], v[132:133], v[12:13] op_sel:[0,0] op_sel_hi:[1,0]
    v_pk_mul_f32 v[142:143], v[126:127], v[12:13] op_sel:[0,0] op_sel_hi:[1,0]
    v_pk_mul_f32 v[150:151], v[134:135], v[12:13] op_sel:[0,0] op_sel_hi:[1,0]
    v_pk_fma_f32 v[136:137], v[128:129], v[12:13], v[136:137] op_sel:[0,1,0] op_sel_hi:[1,1,1]
    v_pk_fma_f32 v[144:145], v[120:121], v[12:13], v[144:145] op_sel:[0,1,0] op_sel_hi:[1,1,1] neg_lo:[0,1,0] neg_hi:[0,1,0]
    v_pk_fma_f32 v[138:139], v[130:131], v[12:13], v[138:139] op_sel:[0,1,0] op_sel_hi:[1,1,1]
    v_pk_fma_f32 v[146:147], v[122:123], v[12:13], v[146:147] op_sel:[0,1,0] op_sel_hi:[1,1,1] neg_lo:[0,1,0] neg_hi:[0,1,0]
    v_pk_fma_f32 v[140:141], v[132:133], v[12:13], v[140:141] op_sel:[0,1,0] op_sel_hi:[1,1,1]
    v_pk_fma_f32 v[148:149], v[124:125], v[12:13], v[148:149] op_sel:[0,1,0] op_sel_hi:[1,1,1] neg_lo:[0,1,0] neg_hi:[0,1,0]
    v_pk_fma_f32 v[142:143], v[134:135], v[12:13], v[142:143] op_sel:[0,1,0] op_sel_hi:[1,1,1]
    v_pk_fma_f32 v[150:151], v[126:127], v[12:13], v[150:151] op_sel:[0,1,0] op_sel_hi:[1,1,1] neg_lo:[0,1,0] neg_hi:[0,1,0]
    v_cvt_pk_bf16_f32 v168, v120, v121
    v_cvt_pk_bf16_f32 v169, v122, v123
    v_cvt_pk_bf16_f32 v170, v128, v129
    v_cvt_pk_bf16_f32 v171, v130, v131
    v_cvt_pk_bf16_f32 v196, v124, v125
    v_cvt_pk_bf16_f32 v197, v126, v127
    v_cvt_pk_bf16_f32 v198, v132, v133
    v_cvt_pk_bf16_f32 v199, v134, v135
    v_pk_mul_f32 v[120:121], v[136:137], v[12:13] op_sel:[0,0] op_sel_hi:[1,0]
    v_pk_mul_f32 v[128:129], v[144:145], v[12:13] op_sel:[0,0] op_sel_hi:[1,0]
    v_pk_mul_f32 v[122:123], v[138:139], v[12:13] op_sel:[0,0] op_sel_hi:[1,0]
    v_pk_mul_f32 v[130:131], v[146:147], v[12:13] op_sel:[0,0] op_sel_hi:[1,0]
    v_pk_mul_f32 v[124:125], v[140:141], v[12:13] op_sel:[0,0] op_sel_hi:[1,0]
    v_pk_mul_f32 v[132:133], v[148:149], v[12:13] op_sel:[0,0] op_sel_hi:[1,0]
    v_pk_mul_f32 v[126:127], v[142:143], v[12:13] op_sel:[0,0] op_sel_hi:[1,0]
    v_pk_mul_f32 v[134:135], v[150:151], v[12:13] op_sel:[0,0] op_sel_hi:[1,0]
    v_pk_fma_f32 v[120:121], v[144:145], v[12:13], v[120:121] op_sel:[0,1,0] op_sel_hi:[1,1,1]
    v_pk_fma_f32 v[128:129], v[136:137], v[12:13], v[128:129] op_sel:[0,1,0] op_sel_hi:[1,1,1] neg_lo:[0,1,0] neg_hi:[0,1,0]
    v_pk_fma_f32 v[122:123], v[146:147], v[12:13], v[122:123] op_sel:[0,1,0] op_sel_hi:[1,1,1]
    v_pk_fma_f32 v[130:131], v[138:139], v[12:13], v[130:131] op_sel:[0,1,0] op_sel_hi:[1,1,1] neg_lo:[0,1,0] neg_hi:[0,1,0]
    v_pk_fma_f32 v[124:125], v[148:149], v[12:13], v[124:125] op_sel:[0,1,0] op_sel_hi:[1,1,1]
    v_pk_fma_f32 v[132:133], v[140:141], v[12:13], v[132:133] op_sel:[0,1,0] op_sel_hi:[1,1,1] neg_lo:[0,1,0] neg_hi:[0,1,0]
    v_pk_fma_f32 v[126:127], v[150:151], v[12:13], v[126:127] op_sel:[0,1,0] op_sel_hi:[1,1,1]
    v_pk_fma_f32 v[134:135], v[142:143], v[12:13], v[134:135] op_sel:[0,1,0] op_sel_hi:[1,1,1] neg_lo:[0,1,0] neg_hi:[0,1,0]
    v_cvt_pk_bf16_f32 v172, v136, v137
    v_cvt_pk_bf16_f32 v173, v138, v139
    v_cvt_pk_bf16_f32 v174, v144, v145
    v_cvt_pk_bf16_f32 v175, v146, v147
    v_cvt_pk_bf16_f32 v200, v140, v141
    v_cvt_pk_bf16_f32 v201, v142, v143
    v_cvt_pk_bf16_f32 v202, v148, v149
    v_cvt_pk_bf16_f32 v203, v150, v151
    v_pk_mul_f32 v[136:137], v[120:121], v[12:13] op_sel:[0,0] op_sel_hi:[1,0]
    v_pk_mul_f32 v[144:145], v[128:129], v[12:13] op_sel:[0,0] op_sel_hi:[1,0]
    v_pk_mul_f32 v[138:139], v[122:123], v[12:13] op_sel:[0,0] op_sel_hi:[1,0]
    v_pk_mul_f32 v[146:147], v[130:131], v[12:13] op_sel:[0,0] op_sel_hi:[1,0]
    v_pk_mul_f32 v[140:141], v[124:125], v[12:13] op_sel:[0,0] op_sel_hi:[1,0]
    v_pk_mul_f32 v[148:149], v[132:133], v[12:13] op_sel:[0,0] op_sel_hi:[1,0]
    v_pk_mul_f32 v[142:143], v[126:127], v[12:13] op_sel:[0,0] op_sel_hi:[1,0]
    v_pk_mul_f32 v[150:151], v[134:135], v[12:13] op_sel:[0,0] op_sel_hi:[1,0]
    v_pk_fma_f32 v[136:137], v[128:129], v[12:13], v[136:137] op_sel:[0,1,0] op_sel_hi:[1,1,1]
    v_pk_fma_f32 v[144:145], v[120:121], v[12:13], v[144:145] op_sel:[0,1,0] op_sel_hi:[1,1,1] neg_lo:[0,1,0] neg_hi:[0,1,0]
    v_pk_fma_f32 v[138:139], v[130:131], v[12:13], v[138:139] op_sel:[0,1,0] op_sel_hi:[1,1,1]
    v_pk_fma_f32 v[146:147], v[122:123], v[12:13], v[146:147] op_sel:[0,1,0] op_sel_hi:[1,1,1] neg_lo:[0,1,0] neg_hi:[0,1,0]
    v_pk_fma_f32 v[140:141], v[132:133], v[12:13], v[140:141] op_sel:[0,1,0] op_sel_hi:[1,1,1]
    v_pk_fma_f32 v[148:149], v[124:125], v[12:13], v[148:149] op_sel:[0,1,0] op_sel_hi:[1,1,1] neg_lo:[0,1,0] neg_hi:[0,1,0]
    v_pk_fma_f32 v[142:143], v[134:135], v[12:13], v[142:143] op_sel:[0,1,0] op_sel_hi:[1,1,1]
    v_pk_fma_f32 v[150:151], v[126:127], v[12:13], v[150:151] op_sel:[0,1,0] op_sel_hi:[1,1,1] neg_lo:[0,1,0] neg_hi:[0,1,0]
    v_cvt_pk_bf16_f32 v176, v120, v121
    v_cvt_pk_bf16_f32 v177, v122, v123
    v_cvt_pk_bf16_f32 v178, v128, v129
    v_cvt_pk_bf16_f32 v179, v130, v131
    v_cvt_pk_bf16_f32 v204, v124, v125
    v_cvt_pk_bf16_f32 v205, v126, v127
    v_cvt_pk_bf16_f32 v206, v132, v133
    v_cvt_pk_bf16_f32 v207, v134, v135
    v_pk_mul_f32 v[120:121], v[136:137], v[12:13] op_sel:[0,0] op_sel_hi:[1,0]
    v_pk_mul_f32 v[128:129], v[144:145], v[12:13] op_sel:[0,0] op_sel_hi:[1,0]
    v_pk_mul_f32 v[122:123], v[138:139], v[12:13] op_sel:[0,0] op_sel_hi:[1,0]
    v_pk_mul_f32 v[130:131], v[146:147], v[12:13] op_sel:[0,0] op_sel_hi:[1,0]
    v_pk_mul_f32 v[124:125], v[140:141], v[12:13] op_sel:[0,0] op_sel_hi:[1,0]
    v_pk_mul_f32 v[132:133], v[148:149], v[12:13] op_sel:[0,0] op_sel_hi:[1,0]
    v_pk_mul_f32 v[126:127], v[142:143], v[12:13] op_sel:[0,0] op_sel_hi:[1,0]
    v_pk_mul_f32 v[134:135], v[150:151], v[12:13] op_sel:[0,0] op_sel_hi:[1,0]
    v_pk_fma_f32 v[120:121], v[144:145], v[12:13], v[120:121] op_sel:[0,1,0] op_sel_hi:[1,1,1]
    v_pk_fma_f32 v[128:129], v[136:137], v[12:13], v[128:129] op_sel:[0,1,0] op_sel_hi:[1,1,1] neg_lo:[0,1,0] neg_hi:[0,1,0]
    v_pk_fma_f32 v[122:123], v[146:147], v[12:13], v[122:123] op_sel:[0,1,0] op_sel_hi:[1,1,1]
    v_pk_fma_f32 v[130:131], v[138:139], v[12:13], v[130:131] op_sel:[0,1,0] op_sel_hi:[1,1,1] neg_lo:[0,1,0] neg_hi:[0,1,0]
    v_pk_fma_f32 v[124:125], v[148:149], v[12:13], v[124:125] op_sel:[0,1,0] op_sel_hi:[1,1,1]
    v_pk_fma_f32 v[132:133], v[140:141], v[12:13], v[132:133] op_sel:[0,1,0] op_sel_hi:[1,1,1] neg_lo:[0,1,0] neg_hi:[0,1,0]
    v_pk_fma_f32 v[126:127], v[150:151], v[12:13], v[126:127] op_sel:[0,1,0] op_sel_hi:[1,1,1]
    v_pk_fma_f32 v[134:135], v[142:143], v[12:13], v[134:135] op_sel:[0,1,0] op_sel_hi:[1,1,1] neg_lo:[0,1,0] neg_hi:[0,1,0]
    v_cvt_pk_bf16_f32 v180, v136, v137
    v_cvt_pk_bf16_f32 v181, v138, v139
    v_cvt_pk_bf16_f32 v182, v144, v145
    v_cvt_pk_bf16_f32 v183, v146, v147
    v_cvt_pk_bf16_f32 v208, v140, v141
    v_cvt_pk_bf16_f32 v209, v142, v143
    v_cvt_pk_bf16_f32 v210, v148, v149
    v_cvt_pk_bf16_f32 v211, v150, v151
    v_mul_f32 v123, v123, v10
    v_mul_f32 v131, v131, v10
    v_cvt_pk_bf16_f32 v184, v120, v121
    v_cvt_pk_bf16_f32 v185, v122, v123
    v_cvt_pk_bf16_f32 v186, v128, v129
    v_cvt_pk_bf16_f32 v187, v130, v131
    v_cvt_pk_bf16_f32 v212, v124, v125
    v_cvt_pk_bf16_f32 v213, v126, v127
    v_cvt_pk_bf16_f32 v214, v132, v133
    v_cvt_pk_bf16_f32 v215, v134, v135
Ljoin_12:
    s_lshl_b32 s56, s46, 2
    s_add_u32 s56, s56, s44
    s_min_u32 s57, s56, 13
    v_lshlrev_b32 v5, 6, v2
    v_add_u32 v5, s45, v5
    v_mul_u32_u24 v5, 896, v5
    v_lshlrev_b32 v6, 3, v3
    v_add_u32 v5, v5, v6
    s_lshl_b32 s52, s57, 5
    v_add_u32 v5, s52, v5
    s_mov_b32 s52, 0
    buffer_load_dwordx2 v[64:65], v5, s[8:11], s52 offen offset:0
    s_mov_b32 s52, 0
    buffer_load_dwordx2 v[66:67], v5, s[8:11], s52 offen offset:448
    s_mov_b32 s52, 917504
    buffer_load_dwordx2 v[68:69], v5, s[8:11], s52 offen offset:0
    s_mov_b32 s52, 917504
    buffer_load_dwordx2 v[70:71], v5, s[8:11], s52 offen offset:448
    v_lshlrev_b32 v12, 2, v1
    s_cmp_lg_u32 s44, 0
    s_cbranch_scc1 Lpollskip_23
    v_lshlrev_b32 v5, 6, v1
    s_add_u32 s52, s48, 0x1840000
    s_add_u32 s53, s52, 4096
    s_add_u32 s54, s52, 8192
    s_add_u32 s55, s52, 12288
    s_mov_b32 s51, 0
    s_waitcnt vmcnt(0)
Lpoll_24:
    buffer_load_dword v100, v5, s[12:15], s52 offen sc1
    buffer_load_dword v101, v5, s[12:15], s53 offen sc1
    buffer_load_dword v102, v5, s[12:15], s54 offen sc1
    buffer_load_dword v103, v5, s[12:15], s55 offen sc1
    s_waitcnt vmcnt(0)
    v_xor_b32 v6, s47, v100
    v_xor_b32 v7, s47, v101
    v_or_b32 v6, v6, v7
    v_xor_b32 v7, s47, v102
    v_or_b32 v6, v6, v7
    v_xor_b32 v7, s47, v103
    v_or_b32 v6, v6, v7
    v_cmp_ne_u32 vcc, 0, v6
    s_nop 4
    s_cbranch_vccz Lpolldone_25
    s_add_u32 s51, s51, 1
    s_cmp_lt_u32 s51, 100000
    s_cbranch_scc1 Lpoll_24
Lpolldone_25:
    s_mov_b64 exec, -1
Lpollskip_23:
    s_barrier
    s_mov_b32 s92, s12
    s_mov_b32 s93, s13
    s_cmp_ge_u32 s50, 14
    s_cselect_b32 s94, 0, s14
    s_mov_b32 s95, 0x20000
    s_lshl_b32 s88, s50, 3
    s_lshl_b32 s52, s44, 1
    s_add_u32 s88, s88, s52
    s_mul_i32 s88, s88, 28672
    s_add_u32 s88, s88, 0x900000
    s_and_b32 s89, s49, 3
    v_lshlrev_b32 v254, 4, v1
    s_add_u32 s52, s44, 0
    s_min_u32 s52, s52, 13
    s_mul_i32 s53, s45, 14
    s_add_u32 s52, s52, s53
    s_lshl_b32 s52, s52, 11
    s_add_u32 s52, s52, 0x200000
    buffer_load_dword v104, v12, s[12:15], s52 offen offset:0 sc1
    buffer_load_dword v105, v12, s[12:15], s52 offen offset:256 sc1
    buffer_load_dword v106, v12, s[12:15], s52 offen offset:512 sc1
    buffer_load_dword v107, v12, s[12:15], s52 offen offset:768 sc1
    buffer_load_dword v108, v12, s[12:15], s52 offen offset:1024 sc1
    buffer_load_dword v109, v12, s[12:15], s52 offen offset:1280 sc1
    buffer_load_dword v110, v12, s[12:15], s52 offen offset:1536 sc1
    buffer_load_dword v111, v12, s[12:15], s52 offen offset:1792 sc1
    s_add_u32 s52, s44, 4
    s_min_u32 s52, s52, 13
    s_mul_i32 s53, s45, 14
    s_add_u32 s52, s52, s53
    s_lshl_b32 s52, s52, 11
    s_add_u32 s52, s52, 0x200000
    buffer_load_dword v112, v12, s[12:15], s52 offen offset:0 sc1
    buffer_load_dword v113, v12, s[12:15], s52 offen offset:256 sc1
    buffer_load_dword v114, v12, s[12:15], s52 offen offset:512 sc1
    buffer_load_dword v115, v12, s[12:15], s52 offen offset:768 sc1
    buffer_load_dword v116, v12, s[12:15], s52 offen offset:1024 sc1
    buffer_load_dword v117, v12, s[12:15], s52 offen offset:1280 sc1
    buffer_load_dword v118, v12, s[12:15], s52 offen offset:1536 sc1
    buffer_load_dword v119, v12, s[12:15], s52 offen offset:1792 sc1
    s_add_u32 s52, s44, 8
    s_min_u32 s52, s52, 13
    s_mul_i32 s53, s45, 14
    s_add_u32 s52, s52, s53
    s_lshl_b32 s52, s52, 11
    s_add_u32 s52, s52, 0x200000
    buffer_load_dword v120, v12, s[12:15], s52 offen offset:0 sc1
    buffer_load_dword v121, v12, s[12:15], s52 offen offset:256 sc1
    buffer_load_dword v122, v12, s[12:15], s52 offen offset:512 sc1
    buffer_load_dword v123, v12, s[12:15], s52 offen offset:768 sc1
    buffer_load_dword v124, v12, s[12:15], s52 offen offset:1024 sc1
    buffer_load_dword v125, v12, s[12:15], s52 offen offset:1280 sc1
    buffer_load_dword v126, v12, s[12:15], s52 offen offset:1536 sc1
    buffer_load_dword v127, v12, s[12:15], s52 offen offset:1792 sc1
    s_add_u32 s52, s44, 12
    s_min_u32 s52, s52, 13
    s_mul_i32 s53, s45, 14
    s_add_u32 s52, s52, s53
    s_lshl_b32 s52, s52, 11
    s_add_u32 s52, s52, 0x200000
    buffer_load_dword v128, v12, s[12:15], s52 offen offset:0 sc1
    buffer_load_dword v129, v12, s[12:15], s52 offen offset:256 sc1
    buffer_load_dword v130, v12, s[12:15], s52 offen offset:512 sc1
    buffer_load_dword v131, v12, s[12:15], s52 offen offset:768 sc1
    buffer_load_dword v132, v12, s[12:15], s52 offen offset:1024 sc1
    buffer_load_dword v133, v12, s[12:15], s52 offen offset:1280 sc1
    buffer_load_dword v134, v12, s[12:15], s52 offen offset:1536 sc1
    buffer_load_dword v135, v12, s[12:15], s52 offen offset:1792 sc1
    v_lshlrev_b32 v6, 2, v2
    s_lshl_b32 s52, s45, 7
    s_add_u32 s52, s52, 0x800000
    buffer_load_dword v72, v6, s[12:15], s52 offen offset:0 sc1
    buffer_load_dword v73, v6, s[12:15], s52 offen offset:64 sc1
    v_lshlrev_b32 v11, 4, v1
    s_cmp_lt_u32 s2, 224
    s_cbranch_scc1 Lp2st_26
    s_cmp_ge_u32 s2, 252
    s_cbranch_scc1 Lp2st_26
    s_add_u32 s52, s99, 0
    buffer_store_dwordx4 v[16:19], v11, s[12:15], s52 offen sc1
    s_add_u32 s52, s99, 114688
    buffer_store_dwordx4 v[20:23], v11, s[12:15], s52 offen sc1
    s_add_u32 s52, s99, 229376
    buffer_store_dwordx4 v[24:27], v11, s[12:15], s52 offen sc1
    s_add_u32 s52, s99, 344064
    buffer_store_dwordx4 v[28:31], v11, s[12:15], s52 offen sc1
    s_add_u32 s52, s99, 458752
    buffer_store_dwordx4 v[32:35], v11, s[12:15], s52 offen sc1
    s_add_u32 s52, s99, 573440
    buffer_store_dwordx4 v[36:39], v11, s[12:15], s52 offen sc1
    s_add_u32 s52, s99, 688128
    buffer_store_dwordx4 v[40:43], v11, s[12:15], s52 offen sc1
    s_add_u32 s52, s99, 802816
    buffer_store_dwordx4 v[44:47], v11, s[12:15], s52 offen sc1
    s_add_u32 s52, s99, 917504
    buffer_store_dwordx4 v[48:51], v11, s[12:15], s52 offen sc1
    s_add_u32 s52, s99, 1032192
    buffer_store_dwordx4 v[52:55], v11, s[12:15], s52 offen sc1
    s_add_u32 s52, s99, 1146880
    buffer_store_dwordx4 v[56:59], v11, s[12:15], s52 offen sc1
    s_add_u32 s52, s99, 1261568
    buffer_store_dwordx4 v[60:63], v11, s[12:15], s52 offen sc1
    s_add_u32 s52, s99, 1376256
    buffer_store_dwordx4 v[92:95], v11, s[12:15], s52 offen sc1
    s_add_u32 s52, s99, 1490944
    buffer_store_dwordx4 v[96:99], v11, s[12:15], s52 offen sc1
Lp2st_26:
    s_lshl_b32 s52, s44, 11
    v_add_u32 v12, s52, v11
    s_waitcnt vmcnt(26)
    v_mfma_f32_16x16x32_bf16 v[136:139], v[104:107], v[220:223], 0
    v_mfma_f32_16x16x32_bf16 v[144:147], v[104:107], v[236:239], 0
    v_mfma_f32_16x16x32_bf16 v[140:143], v[104:107], v[224:227], 0
    v_mfma_f32_16x16x32_bf16 v[148:151], v[104:107], v[240:243], 0
    v_mfma_f32_16x16x32_bf16 v[136:139], v[108:111], v[228:231], v[136:139]
    v_mfma_f32_16x16x32_bf16 v[144:147], v[108:111], v[244:247], v[144:147]
    v_mfma_f32_16x16x32_bf16 v[140:143], v[108:111], v[232:235], v[140:143]
    v_mfma_f32_16x16x32_bf16 v[148:151], v[108:111], v[248:251], v[148:151]
    s_nop 4
    v_cvt_pk_bf16_f32 v76, v136, v137
    v_cvt_pk_bf16_f32 v77, v138, v139
    v_cvt_pk_bf16_f32 v78, v144, v145
    v_cvt_pk_bf16_f32 v79, v146, v147
    ds_write_b128 v12, v[76:79] offset:0
    v_cvt_pk_bf16_f32 v80, v140, v141
    v_cvt_pk_bf16_f32 v81, v142, v143
    v_cvt_pk_bf16_f32 v82, v148, v149
    v_cvt_pk_bf16_f32 v83, v150, v151
    ds_write_b128 v12, v[80:83] offset:1024
    s_add_u32 s90, s89, 0
    s_and_b32 s90, s90, 3
    s_mul_i32 s90, s90, 7168
    s_add_u32 s90, s90, s88
    s_add_u32 s91, s90, 28672
    buffer_load_dwordx4 a[0:3], v254, s[92:95], s90 offen offset:0 sc1
    buffer_load_dwordx4 a[112:115], v254, s[92:95], s91 offen offset:0 sc1
    buffer_load_dwordx4 a[4:7], v254, s[92:95], s90 offen offset:1024 sc1
    s_waitcnt vmcnt(21)
    v_mfma_f32_16x16x32_bf16 v[136:139], v[112:115], v[220:223], 0
    v_mfma_f32_16x16x32_bf16 v[144:147], v[112:115], v[236:239], 0
    v_mfma_f32_16x16x32_bf16 v[140:143], v[112:115], v[224:227], 0
    v_mfma_f32_16x16x32_bf16 v[148:151], v[112:115], v[240:243], 0
    v_mfma_f32_16x16x32_bf16 v[136:139], v[116:119], v[228:231], v[136:139]
    v_mfma_f32_16x16x32_bf16 v[144:147], v[116:119], v[244:247], v[144:147]
    v_mfma_f32_16x16x32_bf16 v[140:143], v[116:119], v[232:235], v[140:143]
    v_mfma_f32_16x16x32_bf16 v[148:151], v[116:119], v[248:251], v[148:151]
    s_nop 4
    v_cvt_pk_bf16_f32 v84, v136, v137
    v_cvt_pk_bf16_f32 v85, v138, v139
    v_cvt_pk_bf16_f32 v86, v144, v145
    v_cvt_pk_bf16_f32 v87, v146, v147
    ds_write_b128 v12, v[84:87] offset:8192
    v_cvt_pk_bf16_f32 v88, v140, v141
    v_cvt_pk_bf16_f32 v89, v142, v143
    v_cvt_pk_bf16_f32 v90, v148, v149
    v_cvt_pk_bf16_f32 v91, v150, v151
    ds_write_b128 v12, v[88:91] offset:9216
    buffer_load_dwordx4 a[116:119], v254, s[92:95], s91 offen offset:1024 sc1
    buffer_load_dwordx4 a[8:11], v254, s[92:95], s90 offen offset:2048 sc1
    buffer_load_dwordx4 a[120:123], v254, s[92:95], s91 offen offset:2048 sc1
    s_waitcnt vmcnt(16)
    v_mfma_f32_16x16x32_bf16 v[136:139], v[120:123], v[220:223], 0
    v_mfma_f32_16x16x32_bf16 v[144:147], v[120:123], v[236:239], 0
    v_mfma_f32_16x16x32_bf16 v[140:143], v[120:123], v[224:227], 0
    v_mfma_f32_16x16x32_bf16 v[148:151], v[120:123], v[240:243], 0
    v_mfma_f32_16x16x32_bf16 v[136:139], v[124:127], v[228:231], v[136:139]
    v_mfma_f32_16x16x32_bf16 v[144:147], v[124:127], v[244:247], v[144:147]
    v_mfma_f32_16x16x32_bf16 v[140:143], v[124:127], v[232:235], v[140:143]
    v_mfma_f32_16x16x32_bf16 v[148:151], v[124:127], v[248:251], v[148:151]
    s_nop 4
    v_cvt_pk_bf16_f32 v76, v136, v137
    v_cvt_pk_bf16_f32 v77, v138, v139
    v_cvt_pk_bf16_f32 v78, v144, v145
    v_cvt_pk_bf16_f32 v79, v146, v147
    ds_write_b128 v12, v[76:79] offset:16384
    v_cvt_pk_bf16_f32 v80, v140, v141
    v_cvt_pk_bf16_f32 v81, v142, v143
    v_cvt_pk_bf16_f32 v82, v148, v149
    v_cvt_pk_bf16_f32 v83, v150, v151
    ds_write_b128 v12, v[80:83] offset:17408
    buffer_load_dwordx4 a[12:15], v254, s[92:95], s90 offen offset:3072 sc1
    buffer_load_dwordx4 a[124:127], v254, s[92:95], s91 offen offset:3072 sc1
    s_add_u32 s90, s90, 4096
    s_add_u32 s91, s91, 4096
    buffer_load_dwordx4 a[16:19], v254, s[92:95], s90 offen offset:0 sc1
    s_waitcnt vmcnt(11)
    v_mfma_f32_16x16x32_bf16 v[136:139], v[128:131], v[220:223], 0
    v_mfma_f32_16x16x32_bf16 v[144:147], v[128:131], v[236:239], 0
    v_mfma_f32_16x16x32_bf16 v[140:143], v[128:131], v[224:227], 0
    v_mfma_f32_16x16x32_bf16 v[148:151], v[128:131], v[240:243], 0
    v_mfma_f32_16x16x32_bf16 v[136:139], v[132:135], v[228:231], v[136:139]
    v_mfma_f32_16x16x32_bf16 v[144:147], v[132:135], v[244:247], v[144:147]
    v_mfma_f32_16x16x32_bf16 v[140:143], v[132:135], v[232:235], v[140:143]
    v_mfma_f32_16x16x32_bf16 v[148:151], v[132:135], v[248:251], v[148:151]
    s_cmp_ge_u32 s44, 2
    s_cbranch_scc1 Lskip3_30
    s_nop 2
    v_cvt_pk_bf16_f32 v84, v136, v137
    v_cvt_pk_bf16_f32 v85, v138, v139
    v_cvt_pk_bf16_f32 v86, v144, v145
    v_cvt_pk_bf16_f32 v87, v146, v147
    ds_write_b128 v12, v[84:87] offset:24576
    v_cvt_pk_bf16_f32 v88, v140, v141
    v_cvt_pk_bf16_f32 v89, v142, v143
    v_cvt_pk_bf16_f32 v90, v148, v149
    v_cvt_pk_bf16_f32 v91, v150, v151
    ds_write_b128 v12, v[88:91] offset:25600
Lskip3_30:
    buffer_load_dwordx4 a[128:131], v254, s[92:95], s91 offen offset:0 sc1
    buffer_load_dwordx4 a[20:23], v254, s[92:95], s90 offen offset:1024 sc1
    buffer_load_dwordx4 a[132:135], v254, s[92:95], s91 offen offset:1024 sc1
    s_waitcnt lgkmcnt(0)
    s_barrier
    ds_read_b128 v[16:19], v11 offset:0
    ds_read_b128 v[20:23], v11 offset:1024
    ds_read_b128 v[24:27], v11 offset:2048
    ds_read_b128 v[28:31], v11 offset:3072
    ds_read_b128 v[32:35], v11 offset:4096
    ds_read_b128 v[36:39], v11 offset:5120
    ds_read_b128 v[40:43], v11 offset:6144
    s_waitcnt lgkmcnt(6)
    v_mfma_f32_16x16x32_bf16 v[48:51], v[160:163], v[16:19], 0
    ds_read_b128 v[44:47], v11 offset:7168
    s_waitcnt lgkmcnt(6)
    v_mfma_f32_16x16x32_bf16 v[52:55], v[160:163], v[20:23], 0
    ds_read_b128 v[16:19], v11 offset:8192
    s_waitcnt lgkmcnt(6)
    v_mfma_f32_16x16x32_bf16 v[48:51], v[164:167], v[24:27], v[48:51]
    ds_read_b128 v[20:23], v11 offset:9216
    s_waitcnt lgkmcnt(6)
    v_mfma_f32_16x16x32_bf16 v[52:55], v[164:167], v[28:31], v[52:55]
    ds_read_b128 v[24:27], v11 offset:10240
    s_waitcnt lgkmcnt(6)
    v_mfma_f32_16x16x32_bf16 v[48:51], v[168:171], v[32:35], v[48:51]
    ds_read_b128 v[28:31], v11 offset:11264
    s_waitcnt lgkmcnt(6)
    v_mfma_f32_16x16x32_bf16 v[52:55], v[168:171], v[36:39], v[52:55]
    ds_read_b128 v[32:35], v11 offset:12288
    buffer_load_dwordx4 a[24:27], v254, s[92:95], s90 offen offset:2048 sc1
    s_waitcnt lgkmcnt(6)
    v_mfma_f32_16x16x32_bf16 v[48:51], v[172:175], v[40:43], v[48:51]
    ds_read_b128 v[36:39], v11 offset:13312
    s_waitcnt lgkmcnt(6)
    v_mfma_f32_16x16x32_bf16 v[52:55], v[172:175], v[44:47], v[52:55]
    ds_read_b128 v[40:43], v11 offset:14336
    s_waitcnt lgkmcnt(6)
    v_mfma_f32_16x16x32_bf16 v[48:51], v[176:179], v[16:19], v[48:51]
    ds_read_b128 v[44:47], v11 offset:15360
    s_waitcnt lgkmcnt(6)
    v_mfma_f32_16x16x32_bf16 v[52:55], v[176:179], v[20:23], v[52:55]
    ds_read_b128 v[16:19], v11 offset:16384
    s_waitcnt lgkmcnt(6)
    v_mfma_f32_16x16x32_bf16 v[48:51], v[180:183], v[24:27], v[48:51]
    ds_read_b128 v[20:23], v11 offset:17408
    s_waitcnt lgkmcnt(6)
    v_mfma_f32_16x16x32_bf16 v[52:55], v[180:183], v[28:31], v[52:55]
    ds_read_b128 v[24:27], v11 offset:18432
    buffer_load_dwordx4 a[136:139], v254, s[92:95], s91 offen offset:2048 sc1
    s_waitcnt lgkmcnt(6)
    v_mfma_f32_16x16x32_bf16 v[48:51], v[184:187], v[32:35], v[48:51]
    ds_read_b128 v[28:31], v11 offset:19456
    s_waitcnt lgkmcnt(6)
    v_mfma_f32_16x16x32_bf16 v[52:55], v[184:187], v[36:39], v[52:55]
    ds_read_b128 v[32:35], v11 offset:20480
    s_waitcnt lgkmcnt(6)
    v_mfma_f32_16x16x32_bf16 v[56:59], v[188:191], v[40:43], 0
    ds_read_b128 v[36:39], v11 offset:21504
    s_waitcnt lgkmcnt(6)
    v_mfma_f32_16x16x32_bf16 v[60:63], v[188:191], v[44:47], 0
    ds_read_b128 v[40:43], v11 offset:22528
    s_waitcnt lgkmcnt(6)
    v_mfma_f32_16x16x32_bf16 v[56:59], v[192:195], v[16:19], v[56:59]
    ds_read_b128 v[44:47], v11 offset:23552
    s_waitcnt lgkmcnt(6)
    v_mfma_f32_16x16x32_bf16 v[60:63], v[192:195], v[20:23], v[60:63]
    ds_read_b128 v[16:19], v11 offset:24576
    s_add_u32 s90, s89, 1
    s_and_b32 s90, s90, 3
    s_mul_i32 s90, s90, 7168
    s_add_u32 s90, s90, s88
    s_add_u32 s91, s90, 28672
    buffer_load_dwordx4 a[28:31], v254, s[92:95], s90 offen offset:0 sc1
    s_waitcnt lgkmcnt(6)
    v_mfma_f32_16x16x32_bf16 v[56:59], v[196:199], v[24:27], v[56:59]
    ds_read_b128 v[20:23], v11 offset:25600
    s_waitcnt lgkmcnt(6)
    v_mfma_f32_16x16x32_bf16 v[60:63], v[196:199], v[28:31], v[60:63]
    ds_read_b128 v[24:27], v11 offset:26624
    s_waitcnt lgkmcnt(6)
    v_mfma_f32_16x16x32_bf16 v[56:59], v[200:203], v[32:35], v[56:59]
    ds_read_b128 v[28:31], v11 offset:27648
    s_waitcnt lgkmcnt(6)
    v_mfma_f32_16x16x32_bf16 v[60:63], v[200:203], v[36:39], v[60:63]
    s_waitcnt lgkmcnt(5)
    v_mfma_f32_16x16x32_bf16 v[56:59], v[204:207], v[40:43], v[56:59]
    s_waitcnt lgkmcnt(4)
    v_mfma_f32_16x16x32_bf16 v[60:63], v[204:207], v[44:47], v[60:63]
    buffer_load_dwordx4 a[140:143], v254, s[92:95], s91 offen offset:0 sc1
    s_waitcnt lgkmcnt(3)
    v_mfma_f32_16x16x32_bf16 v[56:59], v[208:211], v[16:19], v[56:59]
    s_waitcnt lgkmcnt(2)
    v_mfma_f32_16x16x32_bf16 v[60:63], v[208:211], v[20:23], v[60:63]
    s_waitcnt lgkmcnt(1)
    v_mfma_f32_16x16x32_bf16 v[56:59], v[212:215], v[24:27], v[56:59]
    s_waitcnt lgkmcnt(0)
    v_mfma_f32_16x16x32_bf16 v[60:63], v[212:215], v[28:31], v[60:63]
    s_waitcnt vmcnt(16)
    s_mov_b32 s52, 0xffff0000
    s_nop 3
    v_add_f32 v104, v48, v56
    v_lshlrev_b32 v96, 16, v64
    v_add_f32 v105, v49, v57
    v_and_b32 v97, s52, v64
    v_add_f32 v106, v50, v58
    v_lshlrev_b32 v98, 16, v65
    v_add_f32 v107, v51, v59
    v_and_b32 v99, s52, v65
    v_add_f32 v104, v104, v96
    v_add_f32 v105, v105, v97
    v_add_f32 v106, v106, v98
    v_add_f32 v107, v107, v99
    v_cvt_pk_bf16_f32 v120, v104, v105
    v_cvt_pk_bf16_f32 v121, v106, v107
    v_sub_f32 v108, v48, v56
    v_lshlrev_b32 v96, 16, v66
    v_sub_f32 v109, v49, v57
    v_and_b32 v97, s52, v66
    v_sub_f32 v110, v50, v58
    v_lshlrev_b32 v98, 16, v67
    v_sub_f32 v111, v51, v59
    v_and_b32 v99, s52, v67
    v_add_f32 v108, v108, v96
    v_add_f32 v109, v109, v97
    v_add_f32 v110, v110, v98
    v_add_f32 v111, v111, v99
    v_cvt_pk_bf16_f32 v122, v108, v109
    v_cvt_pk_bf16_f32 v123, v110, v111
    v_mov_b32 v92, 0
    v_lshlrev_b32 v100, 16, v120
    v_and_b32 v101, s52, v120
    v_sub_f32 v100, v100, v72
    v_sub_f32 v101, v101, v72
    v_fma_f32 v92, v100, v100, v92
    v_fma_f32 v92, v101, v101, v92
    v_cvt_pk_bf16_f32 v128, v100, v101
    buffer_load_dwordx4 a[32:35], v254, s[92:95], s90 offen offset:1024 sc1
    v_lshlrev_b32 v100, 16, v121
    v_and_b32 v101, s52, v121
    v_sub_f32 v100, v100, v72
    v_sub_f32 v101, v101, v72
    v_fma_f32 v92, v100, v100, v92
    v_fma_f32 v92, v101, v101, v92
    v_cvt_pk_bf16_f32 v129, v100, v101
    buffer_load_dwordx4 a[144:147], v254, s[92:95], s91 offen offset:1024 sc1
    v_lshlrev_b32 v100, 16, v122
    v_and_b32 v101, s52, v122
    v_sub_f32 v100, v100, v72
    v_sub_f32 v101, v101, v72
    v_fma_f32 v92, v100, v100, v92
    v_fma_f32 v92, v101, v101, v92
    v_cvt_pk_bf16_f32 v130, v100, v101
    buffer_load_dwordx4 a[36:39], v254, s[92:95], s90 offen offset:2048 sc1
    v_lshlrev_b32 v100, 16, v123
    v_and_b32 v101, s52, v123
    v_sub_f32 v100, v100, v72
    v_sub_f32 v101, v101, v72
    v_fma_f32 v92, v100, v100, v92
    v_fma_f32 v92, v101, v101, v92
    v_cvt_pk_bf16_f32 v131, v100, v101
    buffer_load_dwordx4 a[148:151], v254, s[92:95], s91 offen offset:2048 sc1
    v_add_f32 v112, v52, v60
    v_lshlrev_b32 v96, 16, v68
    v_add_f32 v113, v53, v61
    v_and_b32 v97, s52, v68
    v_add_f32 v114, v54, v62
    v_lshlrev_b32 v98, 16, v69
    v_add_f32 v115, v55, v63
    v_and_b32 v99, s52, v69
    v_add_f32 v112, v112, v96
    v_add_f32 v113, v113, v97
    v_add_f32 v114, v114, v98
    v_add_f32 v115, v115, v99
    v_cvt_pk_bf16_f32 v124, v112, v113
    v_cvt_pk_bf16_f32 v125, v114, v115
    v_sub_f32 v116, v52, v60
    v_lshlrev_b32 v96, 16, v70
    v_sub_f32 v117, v53, v61
    v_and_b32 v97, s52, v70
    v_sub_f32 v118, v54, v62
    v_lshlrev_b32 v98, 16, v71
    v_sub_f32 v119, v55, v63
    v_and_b32 v99, s52, v71
    v_add_f32 v116, v116, v96
    v_add_f32 v117, v117, v97
    v_add_f32 v118, v118, v98
    v_add_f32 v119, v119, v99
    v_cvt_pk_bf16_f32 v126, v116, v117
    v_cvt_pk_bf16_f32 v127, v118, v119
    v_mov_b32 v93, 0
    v_lshlrev_b32 v100, 16, v124
    v_and_b32 v101, s52, v124
    v_sub_f32 v100, v100, v73
    v_sub_f32 v101, v101, v73
    v_fma_f32 v93, v100, v100, v93
    v_fma_f32 v93, v101, v101, v93
    v_cvt_pk_bf16_f32 v132, v100, v101
    buffer_load_dwordx4 a[40:43], v254, s[92:95], s90 offen offset:3072 sc1
    v_lshlrev_b32 v100, 16, v125
    v_and_b32 v101, s52, v125
    v_sub_f32 v100, v100, v73
    v_sub_f32 v101, v101, v73
    v_fma_f32 v93, v100, v100, v93
    v_fma_f32 v93, v101, v101, v93
    v_cvt_pk_bf16_f32 v133, v100, v101
    buffer_load_dwordx4 a[152:155], v254, s[92:95], s91 offen offset:3072 sc1
    v_lshlrev_b32 v100, 16, v126
    v_and_b32 v101, s52, v126
    v_sub_f32 v100, v100, v73
    v_sub_f32 v101, v101, v73
    v_fma_f32 v93, v100, v100, v93
    v_fma_f32 v93, v101, v101, v93
    v_cvt_pk_bf16_f32 v134, v100, v101
    s_add_u32 s90, s90, 4096
    s_add_u32 s91, s91, 4096
    buffer_load_dwordx4 a[44:47], v254, s[92:95], s90 offen offset:0 sc1
    v_lshlrev_b32 v100, 16, v127
    v_and_b32 v101, s52, v127
    v_sub_f32 v100, v100, v73
    v_sub_f32 v101, v101, v73
    v_fma_f32 v93, v100, v100, v93
    v_fma_f32 v93, v101, v101, v93
    v_cvt_pk_bf16_f32 v135, v100, v101
    buffer_load_dwordx4 a[156:159], v254, s[92:95], s91 offen offset:0 sc1
    v_lshrrev_b32 v4, 1, v3
    v_lshlrev_b32 v4, 10, v4
    v_and_b32 v5, 1, v3
    v_lshlrev_b32 v5, 9, v5
    v_add_u32 v4, v4, v5
    v_lshlrev_b32 v5, 4, v2
    v_add_u32 v4, v4, v5
    s_mul_i32 s52, s45, 28
    s_lshl_b32 s53, s57, 1
    s_add_u32 s52, s52, s53
    s_lshl_b32 s52, s52, 10
    s_cmp_ge_u32 s56, 14
    s_cbranch_scc1 Lcnostore_31
    s_add_u32 s53, s52, 0x400000
    s_add_u32 s54, s52, 0x600000
    buffer_store_dwordx4 v[128:131], v4, s[12:15], s53 offen offset:0 sc1
    buffer_store_dwordx4 v[120:123], v4, s[12:15], s54 offen offset:0 sc1
    buffer_store_dwordx4 v[132:135], v4, s[12:15], s53 offen offset:256 sc1
    buffer_store_dwordx4 v[124:127], v4, s[12:15], s54 offen offset:256 sc1
Lcnostore_31:
    v_mov_b32 v102, v92
    s_nop 1
    v_permlane32_swap_b32 v102, v92
    v_add_f32 v92, v92, v102
    v_mov_b32 v102, v92
    s_nop 1
    v_permlane16_swap_b32 v102, v92
    v_add_f32 v92, v92, v102
    v_mov_b32 v102, v93
    s_nop 1
    v_permlane32_swap_b32 v102, v93
    v_add_f32 v93, v93, v102
    v_mov_b32 v102, v93
    s_nop 1
    v_permlane16_swap_b32 v102, v93
    v_add_f32 v93, v93, v102
    s_cmp_lt_u32 s56, 14
    s_cbranch_scc1 Lcstat_32
    v_mov_b32 v92, 0
    v_mov_b32 v93, 0
Lcstat_32:
    v_cmp_le_u32 vcc, 16, v1
    s_nop 1
    v_cndmask_b32 v92, v92, v93, vcc
    v_lshlrev_b32 v5, 2, v1
    s_lshl_b32 s52, s45, 11
    s_lshl_b32 s53, s56, 7
    s_add_u32 s52, s52, s53
    s_add_u32 s52, s52, 0x810000
    s_mov_b64 exec, 0xffffffff
    buffer_store_dword v92, v5, s[12:15], s52 offen sc1
    s_mov_b64 exec, -1
    buffer_load_dwordx4 a[48:51], v254, s[92:95], s90 offen offset:1024 sc1
    buffer_load_dwordx4 a[160:163], v254, s[92:95], s91 offen offset:1024 sc1
    buffer_load_dwordx4 a[52:55], v254, s[92:95], s90 offen offset:2048 sc1
    buffer_load_dwordx4 a[164:167], v254, s[92:95], s91 offen offset:2048 sc1
    s_add_u32 s90, s89, 2
    s_and_b32 s90, s90, 3
    s_mul_i32 s90, s90, 7168
    s_add_u32 s90, s90, s88
    s_add_u32 s91, s90, 28672
    buffer_load_dwordx4 a[56:59], v254, s[92:95], s90 offen offset:0 sc1
    buffer_load_dwordx4 a[168:171], v254, s[92:95], s91 offen offset:0 sc1
    buffer_load_dwordx4 a[60:63], v254, s[92:95], s90 offen offset:1024 sc1
    buffer_load_dwordx4 a[172:175], v254, s[92:95], s91 offen offset:1024 sc1
    s_waitcnt vmcnt(8)
    s_barrier
    s_cmp_lg_u32 s44, 0
    s_cbranch_scc1 Lsig_33
    s_lshl_b32 s52, s2, 6
    s_add_u32 s52, s52, 0x1880000
    v_mov_b32 v14, s47
    v_lshlrev_b32 v15, 14, v1
    s_mov_b64 exec, 0xff
    buffer_store_dword v14, v15, s[12:15], s52 offen sc1
    s_mov_b64 exec, -1
Lsig_33:
    buffer_load_dwordx4 a[64:67], v254, s[92:95], s90 offen offset:2048 sc1
    buffer_load_dwordx4 a[176:179], v254, s[92:95], s91 offen offset:2048 sc1
    buffer_load_dwordx4 a[68:71], v254, s[92:95], s90 offen offset:3072 sc1
    buffer_load_dwordx4 a[180:183], v254, s[92:95], s91 offen offset:3072 sc1
    s_add_u32 s90, s90, 4096
    s_add_u32 s91, s91, 4096
    buffer_load_dwordx4 a[72:75], v254, s[92:95], s90 offen offset:0 sc1
    buffer_load_dwordx4 a[184:187], v254, s[92:95], s91 offen offset:0 sc1
    buffer_load_dwordx4 a[76:79], v254, s[92:95], s90 offen offset:1024 sc1
    buffer_load_dwordx4 a[188:191], v254, s[92:95], s91 offen offset:1024 sc1
    buffer_load_dwordx4 a[80:83], v254, s[92:95], s90 offen offset:2048 sc1
    buffer_load_dwordx4 a[192:195], v254, s[92:95], s91 offen offset:2048 sc1
    s_add_u32 s90, s89, 3
    s_and_b32 s90, s90, 3
    s_mul_i32 s90, s90, 7168
    s_add_u32 s90, s90, s88
    s_add_u32 s91, s90, 28672
    buffer_load_dwordx4 a[84:87], v254, s[92:95], s90 offen offset:0 sc1
    buffer_load_dwordx4 a[196:199], v254, s[92:95], s91 offen offset:0 sc1
    buffer_load_dwordx4 a[88:91], v254, s[92:95], s90 offen offset:1024 sc1
    buffer_load_dwordx4 a[200:203], v254, s[92:95], s91 offen offset:1024 sc1
    buffer_load_dwordx4 a[92:95], v254, s[92:95], s90 offen offset:2048 sc1
    buffer_load_dwordx4 a[204:207], v254, s[92:95], s91 offen offset:2048 sc1
    v_lshlrev_b32 v4, 4, v1
    s_lshl_b32 s56, s50, 3
    s_lshl_b32 s52, s44, 1
    s_add_u32 s56, s56, s52
    s_lshl_b32 s57, s49, 2
    s_and_b32 s58, s2, 7
    s_lshr_b32 s59, s2, 3
    s_mul_i32 s52, s59, 37
    s_lshr_b32 s52, s52, 8
    s_mul_i32 s53, s52, 7
    s_sub_u32 s59, s59, s53
    s_lshl_b32 s52, s52, 3
    s_add_u32 s58, s58, s52
    s_mul_i32 s52, s44, 28
    s_and_b32 s54, s44, 1
    s_xor_b32 s53, s54, 0
    s_lshl_b32 s55, s59, 1
    s_add_u32 s53, s53, s55
    s_mul_i32 s53, s53, 112
    s_add_u32 s53, s53, s52
    s_lshl_b32 s53, s53, 10
    s_add_u32 s60, s53, 0xd00000
    s_xor_b32 s53, s54, 1
    s_lshl_b32 s55, s59, 1
    s_add_u32 s53, s53, s55
    s_mul_i32 s53, s53, 112
    s_add_u32 s53, s53, s52
    s_lshl_b32 s53, s53, 10
    s_add_u32 s61, s53, 0xd00000
    s_lshr_b32 s53, s44, 1
    s_lshl_b32 s53, s53, 4
    v_xor_b32 v10, s53, v1
    v_lshlrev_b32 v10, 4, v10
    v_min_u32 v8, 13, v1
    v_lshrrev_b32 v9, 1, v8
    v_and_b32 v8, 1, v8
    v_lshlrev_b32 v8, 7, v8
    v_add_u32 v8, v8, v9
    s_lshr_b32 s53, s58, 1
    s_lshl_b32 s53, s53, 3
    v_add_u32 v8, s53, v8
    v_lshlrev_b32 v8, 6, v8
    s_add_u32 s52, s44, 0
    s_mul_i32 s53, s52, 37
    s_lshr_b32 s53, s53, 8
    s_mul_i32 s54, s53, 7
    s_sub_u32 s54, s52, s54
    s_add_u32 s53, s53, s49
    s_and_b32 s53, s53, 3
    s_mul_i32 s53, s53, 7
    s_add_u32 s53, s53, s54
    s_mul_i32 s54, s57, 28
    s_add_u32 s53, s53, s54
    s_lshl_b32 s53, s53, 10
    s_add_u32 s64, s53, 0x400000
    s_add_u32 s52, s44, 4
    s_mul_i32 s53, s52, 37
    s_lshr_b32 s53, s53, 8
    s_mul_i32 s54, s53, 7
    s_sub_u32 s54, s52, s54
    s_add_u32 s53, s53, s49
    s_and_b32 s53, s53, 3
    s_mul_i32 s53, s53, 7
    s_add_u32 s53, s53, s54
    s_mul_i32 s54, s57, 28
    s_add_u32 s53, s53, s54
    s_lshl_b32 s53, s53, 10
    s_add_u32 s65, s53, 0x400000
    s_add_u32 s52, s44, 8
    s_mul_i32 s53, s52, 37
    s_lshr_b32 s53, s53, 8
    s_mul_i32 s54, s53, 7
    s_sub_u32 s54, s52, s54
    s_add_u32 s53, s53, s49
    s_and_b32 s53, s53, 3
    s_mul_i32 s53, s53, 7
    s_add_u32 s53, s53, s54
    s_mul_i32 s54, s57, 28
    s_add_u32 s53, s53, s54
    s_lshl_b32 s53, s53, 10
    s_add_u32 s66, s53, 0x400000
    s_add_u32 s52, s44, 12
    s_mul_i32 s53, s52, 37
    s_lshr_b32 s53, s53, 8
    s_mul_i32 s54, s53, 7
    s_sub_u32 s54, s52, s54
    s_add_u32 s53, s53, s49
    s_and_b32 s53, s53, 3
    s_mul_i32 s53, s53, 7
    s_add_u32 s53, s53, s54
    s_mul_i32 s54, s57, 28
    s_add_u32 s53, s53, s54
    s_lshl_b32 s53, s53, 10
    s_add_u32 s67, s53, 0x400000
    s_add_u32 s52, s44, 16
    s_mul_i32 s53, s52, 37
    s_lshr_b32 s53, s53, 8
    s_mul_i32 s54, s53, 7
    s_sub_u32 s54, s52, s54
    s_add_u32 s53, s53, s49
    s_and_b32 s53, s53, 3
    s_mul_i32 s53, s53, 7
    s_add_u32 s53, s53, s54
    s_mul_i32 s54, s57, 28
    s_add_u32 s53, s53, s54
    s_lshl_b32 s53, s53, 10
    s_add_u32 s68, s53, 0x400000
    s_add_u32 s52, s44, 20
    s_mul_i32 s53, s52, 37
    s_lshr_b32 s53, s53, 8
    s_mul_i32 s54, s53, 7
    s_sub_u32 s54, s52, s54
    s_add_u32 s53, s53, s49
    s_and_b32 s53, s53, 3
    s_mul_i32 s53, s53, 7
    s_add_u32 s53, s53, s54
    s_mul_i32 s54, s57, 28
    s_add_u32 s53, s53, s54
    s_lshl_b32 s53, s53, 10
    s_add_u32 s69, s53, 0x400000
    s_add_u32 s52, s44, 24
    s_mul_i32 s53, s52, 37
    s_lshr_b32 s53, s53, 8
    s_mul_i32 s54, s53, 7
    s_sub_u32 s54, s52, s54
    s_add_u32 s53, s53, s49
    s_and_b32 s53, s53, 3
    s_mul_i32 s53, s53, 7
    s_add_u32 s53, s53, s54
    s_mul_i32 s54, s57, 28
    s_add_u32 s53, s53, s54
    s_lshl_b32 s53, s53, 10
    s_add_u32 s70, s53, 0x400000
    s_lshl_b32 s71, s44, 10
    s_cmp_ge_u32 s50, 14
    s_cbranch_scc1 L_g2only
    s_cmp_lg_u32 s44, 0
    s_cbranch_scc1 Lpollskip_34
    v_lshrrev_b32 v5, 2, v1
    v_add_u32 v5, s57, v5
    v_and_b32 v6, 7, v5
    v_lshrrev_b32 v5, 3, v5
    v_lshlrev_b32 v5, 5, v5
    v_add_u32 v5, v5, v6
    v_and_b32 v6, 3, v1
    v_lshlrev_b32 v6, 3, v6
    v_add_u32 v5, v5, v6
    v_lshlrev_b32 v5, 6, v5
    s_add_u32 s52, s48, 0x1880000
    s_mov_b32 s51, 0
    s_mov_b64 exec, 0xffff
    s_waitcnt vmcnt(0)
Lpoll_35:
    buffer_load_dword v232, v5, s[12:15], s52 offen sc1
    s_waitcnt vmcnt(0)
    v_xor_b32 v6, s47, v232
    v_cmp_ne_u32 vcc, 0, v6
    s_nop 4
    s_cbranch_vccz Lpolldone_36
    s_add_u32 s51, s51, 1
    s_cmp_lt_u32 s51, 100000
    s_cbranch_scc1 Lpoll_35
Lpolldone_36:
    s_mov_b64 exec, -1
Lpollskip_34:
    s_barrier
    s_mul_i32 s96, s44, 7168
    s_add_u32 s98, s49, s44
    s_and_b32 s98, s98, 3
    s_mul_i32 s98, s98, 7168
    s_add_u32 m0, s71, 0
    s_nop 0
    buffer_load_dwordx4 v4, s[12:15], s64 offen sc1 lds
    s_add_u32 m0, s71, 4096
    s_nop 0
    buffer_load_dwordx4 v4, s[12:15], s65 offen sc1 lds
    s_add_u32 m0, s71, 8192
    s_nop 0
    buffer_load_dwordx4 v4, s[12:15], s66 offen sc1 lds
    s_add_u32 m0, s71, 12288
    s_nop 0
    buffer_load_dwordx4 v4, s[12:15], s67 offen sc1 lds
    s_add_u32 m0, s71, 16384
    s_nop 0
    buffer_load_dwordx4 v4, s[12:15], s68 offen sc1 lds
    s_add_u32 m0, s71, 20480
    s_nop 0
    buffer_load_dwordx4 v4, s[12:15], s69 offen sc1 lds
    s_add_u32 m0, s71, 24576
    s_nop 0
    buffer_load_dwordx4 v4, s[12:15], s70 offen sc1 lds
    s_add_u32 s54, s57, s44
    s_lshl_b32 s54, s54, 11
    s_add_u32 s54, s54, 0x810000
    s_lshl_b32 s55, s44, 11
    s_add_u32 m0, s55, 114688
    s_nop 0
    buffer_load_dwordx4 v4, s[12:15], s54 offen sc1 lds
    buffer_load_dwordx4 v4, s[12:15], s54 offen offset:1024 sc1 lds
    buffer_load_dwordx4 a[96:99], v254, s[92:95], s90 offen offset:3072 sc1
    buffer_load_dwordx4 a[208:211], v254, s[92:95], s91 offen offset:3072 sc1
    s_add_u32 s90, s90, 4096
    s_add_u32 s91, s91, 4096
    buffer_load_dwordx4 a[100:103], v254, s[92:95], s90 offen offset:0 sc1
    buffer_load_dwordx4 a[212:215], v254, s[92:95], s91 offen offset:0 sc1
    buffer_load_dwordx4 a[104:107], v254, s[92:95], s90 offen offset:1024 sc1
    buffer_load_dwordx4 a[216:219], v254, s[92:95], s91 offen offset:1024 sc1
    buffer_load_dwordx4 a[108:111], v254, s[92:95], s90 offen offset:2048 sc1
    buffer_load_dwordx4 a[220:223], v254, s[92:95], s91 offen offset:2048 sc1
    v_add_u32 v6, 57344, v4
    v_and_b32 v5, 31, v1
    v_lshlrev_b32 v5, 2, v5
    v_lshrrev_b32 v7, 5, v1
    v_lshlrev_b32 v7, 10, v7
    v_add_u32 v5, v5, v7
    v_add_u32 v5, 114688, v5
    s_mul_i32 s99, s57, 112
    s_add_u32 s99, s99, s56
    s_lshl_b32 s99, s99, 10
    s_add_u32 s99, s99, 0x1000000
    s_lshr_b32 s52, s58, 1
    s_lshl_b32 s52, s52, 2
    s_and_b32 s53, s58, 1
    s_add_u32 s100, s52, s53
    s_sub_u32 s101, s52, s53
    s_add_u32 s101, s101, 3
    s_mul_i32 s52, s44, 28
    s_mul_i32 s53, s100, 112
    s_add_u32 s53, s53, s52
    s_lshl_b32 s53, s53, 10
    s_add_u32 s88, s53, 0x1000000
    s_mul_i32 s53, s101, 112
    s_add_u32 s53, s53, s52
    s_lshl_b32 s53, s53, 10
    s_add_u32 s89, s53, 0x1000000
    s_waitcnt vmcnt(15)
    s_barrier
    ds_read_b128 v[16:19], v4 offset:0
    ds_read_b128 v[20:23], v4 offset:1024
    ds_read_b128 v[24:27], v4 offset:2048
    ds_read_b128 v[28:31], v4 offset:3072
    ds_read_b128 v[32:35], v4 offset:4096
    s_waitcnt lgkmcnt(4)
    v_mfma_f32_32x32x16_bf16 v[64:79], a[0:3], v[16:19], 0
    ds_read_b128 v[36:39], v4 offset:5120
    s_add_u32 s97, s57, 1
    s_mul_i32 s97, s97, 28672
    s_add_u32 s97, s97, s98
    s_add_u32 s97, s97, 0x400000
    s_add_u32 m0, s96, 28672
    s_nop 0
    buffer_load_dwordx4 v4, s[12:15], s97 offen offset:0 sc1 lds
    v_mfma_f32_32x32x16_bf16 v[80:95], a[112:115], v[16:19], 0
    s_waitcnt lgkmcnt(4)
    v_mfma_f32_32x32x16_bf16 v[64:79], a[4:7], v[20:23], v[64:79]
    ds_read_b128 v[40:43], v4 offset:6144
    v_mfma_f32_32x32x16_bf16 v[80:95], a[116:119], v[20:23], v[80:95]
    s_waitcnt lgkmcnt(4)
    v_mfma_f32_32x32x16_bf16 v[64:79], a[8:11], v[24:27], v[64:79]
    ds_read_b128 v[44:47], v4 offset:7168
    buffer_load_dwordx4 v4, s[12:15], s97 offen offset:1024 sc1 lds
    v_mfma_f32_32x32x16_bf16 v[80:95], a[120:123], v[24:27], v[80:95]
    s_waitcnt vmcnt(15)
    s_barrier
    s_waitcnt lgkmcnt(4)
    v_mfma_f32_32x32x16_bf16 v[64:79], a[12:15], v[28:31], v[64:79]
    ds_read_b128 v[16:19], v4 offset:8192
    v_mfma_f32_32x32x16_bf16 v[80:95], a[124:127], v[28:31], v[80:95]
    s_waitcnt lgkmcnt(4)
    v_mfma_f32_32x32x16_bf16 v[64:79], a[16:19], v[32:35], v[64:79]
    ds_read_b128 v[20:23], v4 offset:9216
    buffer_load_dwordx4 v4, s[12:15], s97 offen offset:2048 sc1 lds
    v_mfma_f32_32x32x16_bf16 v[80:95], a[128:131], v[32:35], v[80:95]
    s_waitcnt lgkmcnt(4)
    v_mfma_f32_32x32x16_bf16 v[64:79], a[20:23], v[36:39], v[64:79]
    ds_read_b128 v[24:27], v4 offset:10240
    v_mfma_f32_32x32x16_bf16 v[80:95], a[132:135], v[36:39], v[80:95]
    s_waitcnt lgkmcnt(4)
    v_mfma_f32_32x32x16_bf16 v[64:79], a[24:27], v[40:43], v[64:79]
    ds_read_b128 v[28:31], v4 offset:11264
    buffer_load_dwordx4 v4, s[12:15], s97 offen offset:3072 sc1 lds
    v_mfma_f32_32x32x16_bf16 v[80:95], a[136:139], v[40:43], v[80:95]
    s_waitcnt lgkmcnt(4)
    v_mfma_f32_32x32x16_bf16 v[64:79], a[28:31], v[44:47], v[64:79]
    ds_read_b128 v[32:35], v4 offset:12288
    v_mfma_f32_32x32x16_bf16 v[80:95], a[140:143], v[44:47], v[80:95]
    s_waitcnt lgkmcnt(4)
    v_mfma_f32_32x32x16_bf16 v[64:79], a[32:35], v[16:19], v[64:79]
    ds_read_b128 v[36:39], v4 offset:13312
    s_add_u32 s97, s97, 4096
    s_add_u32 m0, s96, 32768
    s_nop 0
    buffer_load_dwordx4 v4, s[12:15], s97 offen offset:0 sc1 lds
    v_mfma_f32_32x32x16_bf16 v[80:95], a[144:147], v[16:19], v[80:95]
    s_waitcnt lgkmcnt(4)
    v_mfma_f32_32x32x16_bf16 v[64:79], a[36:39], v[20:23], v[64:79]
    ds_read_b128 v[40:43], v4 offset:14336
    v_mfma_f32_32x32x16_bf16 v[80:95], a[148:151], v[20:23], v[80:95]
    s_waitcnt lgkmcnt(4)
    v_mfma_f32_32x32x16_bf16 v[64:79], a[40:43], v[24:27], v[64:79]
    ds_read_b128 v[44:47], v4 offset:15360
    buffer_load_dwordx4 v4, s[12:15], s97 offen offset:1024 sc1 lds
    v_mfma_f32_32x32x16_bf16 v[80:95], a[152:155], v[24:27], v[80:95]
    s_waitcnt vmcnt(14)
    s_barrier
    s_waitcnt lgkmcnt(4)
    v_mfma_f32_32x32x16_bf16 v[64:79], a[44:47], v[28:31], v[64:79]
    ds_read_b128 v[16:19], v4 offset:16384
    v_mfma_f32_32x32x16_bf16 v[80:95], a[156:159], v[28:31], v[80:95]
    s_waitcnt lgkmcnt(4)
    v_mfma_f32_32x32x16_bf16 v[64:79], a[48:51], v[32:35], v[64:79]
    ds_read_b128 v[20:23], v4 offset:17408
    buffer_load_dwordx4 v4, s[12:15], s97 offen offset:2048 sc1 lds
    ds_read_b32 v208, v5 offset:0
    ds_read_b32 v209, v5 offset:128
    ds_read_b32 v210, v5 offset:256
    ds_read_b32 v211, v5 offset:384
    v_mfma_f32_32x32x16_bf16 v[80:95], a[160:163], v[32:35], v[80:95]
    ds_read_b32 v212, v5 offset:512
    ds_read_b32 v213, v5 offset:640
    ds_read_b32 v214, v5 offset:768
    s_waitcnt lgkmcnt(11)
    v_mfma_f32_32x32x16_bf16 v[64:79], a[52:55], v[36:39], v[64:79]
    ds_read_b128 v[24:27], v4 offset:18432
    ds_read_b32 v215, v5 offset:896
    ds_read_b32 v216, v5 offset:2048
    ds_read_b32 v217, v5 offset:2176
    v_mfma_f32_32x32x16_bf16 v[80:95], a[164:167], v[36:39], v[80:95]
    v_min_u32 v9, 27, v1
    v_add_u32 v9, 224, v9
    v_lshlrev_b32 v11, 6, v9
    s_add_u32 s91, s48, 0x1880000
    buffer_load_dword v9, v11, s[12:15], s91 offen sc1
    s_waitcnt lgkmcnt(14)
    ds_read_b32 v218, v5 offset:2304
    s_waitcnt lgkmcnt(14)
    ds_read_b32 v219, v5 offset:2432
    s_waitcnt lgkmcnt(14)
    ds_read_b32 v220, v5 offset:2560
    s_waitcnt lgkmcnt(14)
    ds_read_b32 v221, v5 offset:2688
    v_mfma_f32_32x32x16_bf16 v[64:79], a[56:59], v[40:43], v[64:79]
    s_waitcnt lgkmcnt(14)
    ds_read_b128 v[28:31], v4 offset:19456
    s_add_u32 s97, s57, 2
    s_mul_i32 s97, s97, 28672
    s_add_u32 s97, s97, s98
    s_add_u32 s97, s97, 0x400000
    s_add_u32 m0, s96, 57344
    s_nop 0
    buffer_load_dwordx4 v4, s[12:15], s97 offen offset:0 sc1 lds
    s_waitcnt lgkmcnt(14)
    ds_read_b32 v222, v5 offset:2816
    s_waitcnt lgkmcnt(14)
    ds_read_b32 v223, v5 offset:2944
    s_waitcnt lgkmcnt(14)
    ds_read_b32 v224, v5 offset:4096
    v_mfma_f32_32x32x16_bf16 v[80:95], a[168:171], v[40:43], v[80:95]
    s_waitcnt lgkmcnt(14)
    ds_read_b32 v225, v5 offset:4224
    s_waitcnt lgkmcnt(14)
    ds_read_b32 v226, v5 offset:4352
    s_waitcnt lgkmcnt(14)
    ds_read_b32 v227, v5 offset:4480
    v_mfma_f32_32x32x16_bf16 v[64:79], a[60:63], v[44:47], v[64:79]
    s_waitcnt lgkmcnt(14)
    ds_read_b128 v[32:35], v4 offset:20480
    s_waitcnt lgkmcnt(14)
    ds_read_b32 v228, v5 offset:4608
    s_waitcnt lgkmcnt(14)
    ds_read_b32 v229, v5 offset:4736
    s_waitcnt lgkmcnt(14)
    ds_read_b32 v230, v5 offset:4864
    s_waitcnt lgkmcnt(14)
    ds_read_b32 v231, v5 offset:4992
    v_mfma_f32_32x32x16_bf16 v[80:95], a[172:175], v[44:47], v[80:95]
    s_waitcnt lgkmcnt(14)
    ds_read_b32 v232, v5 offset:6144
    s_waitcnt lgkmcnt(14)
    ds_read_b32 v233, v5 offset:6272
    s_waitcnt lgkmcnt(14)
    ds_read_b32 v234, v5 offset:6400
    v_mfma_f32_32x32x16_bf16 v[64:79], a[64:67], v[16:19], v[64:79]
    s_waitcnt lgkmcnt(14)
    ds_read_b128 v[36:39], v4 offset:21504
    buffer_load_dwordx4 v4, s[12:15], s97 offen offset:1024 sc1 lds
    s_waitcnt lgkmcnt(14)
    ds_read_b32 v235, v5 offset:6528
    s_waitcnt lgkmcnt(14)
    ds_read_b32 v236, v5 offset:6656
    s_waitcnt lgkmcnt(14)
    ds_read_b32 v237, v5 offset:6784
    v_mfma_f32_32x32x16_bf16 v[80:95], a[176:179], v[16:19], v[80:95]
    s_waitcnt lgkmcnt(14)
    ds_read_b32 v238, v5 offset:6912
    s_waitcnt lgkmcnt(14)
    ds_read_b32 v239, v5 offset:7040
    v_add_f32 v208, v208, v209
    v_mfma_f32_32x32x16_bf16 v[64:79], a[68:71], v[20:23], v[64:79]
    s_waitcnt lgkmcnt(14)
    ds_read_b128 v[40:43], v4 offset:22528
    v_add_f32 v210, v210, v211
    v_add_f32 v212, v212, v213
    v_add_f32 v214, v214, v215
    v_mfma_f32_32x32x16_bf16 v[80:95], a[180:183], v[20:23], v[80:95]
    v_add_f32 v208, v208, v210
    v_add_f32 v212, v212, v214
    v_add_f32 v208, v208, v212
    v_mfma_f32_32x32x16_bf16 v[64:79], a[72:75], v[24:27], v[64:79]
    s_waitcnt lgkmcnt(14)
    ds_read_b128 v[44:47], v4 offset:23552
    buffer_load_dwordx4 v4, s[12:15], s97 offen offset:2048 sc1 lds
    v_mov_b32 v209, v208
    v_mov_b32 v7, 0x3727c5ac
    s_nop 0
    v_permlane32_swap_b32 v209, v208
    v_add_f32 v208, v208, v209
    v_mfma_f32_32x32x16_bf16 v[80:95], a[184:187], v[24:27], v[80:95]
    v_fmamk_f32 v52, v208, 0x3b124925, v7
    v_rsq_f32 v208, v52
    s_nop 0
    v_mfma_f32_32x32x16_bf16 v[64:79], a[76:79], v[28:31], v[64:79]
    s_waitcnt lgkmcnt(14)
    ds_read_b128 v[16:19], v4 offset:24576
    v_mul_f32 v48, 0xbfb8aa3b, v208
    v_add_f32 v216, v216, v217
    v_mfma_f32_32x32x16_bf16 v[80:95], a[188:191], v[28:31], v[80:95]
    v_add_f32 v218, v218, v219
    v_add_f32 v220, v220, v221
    v_add_f32 v222, v222, v223
    v_mfma_f32_32x32x16_bf16 v[64:79], a[80:83], v[32:35], v[64:79]
    s_waitcnt lgkmcnt(14)
    ds_read_b128 v[20:23], v4 offset:25600
    buffer_load_dwordx4 v4, s[12:15], s97 offen offset:3072 sc1 lds
    v_add_f32 v216, v216, v218
    v_add_f32 v220, v220, v222
    v_add_f32 v216, v216, v220
    v_mov_b32 v217, v216
    v_mfma_f32_32x32x16_bf16 v[80:95], a[192:195], v[32:35], v[80:95]
    v_mov_b32 v7, 0x3727c5ac
    v_permlane32_swap_b32 v217, v216
    v_add_f32 v216, v216, v217
    s_waitcnt lgkmcnt(9)
    v_mfma_f32_32x32x16_bf16 v[64:79], a[84:87], v[36:39], v[64:79]
    ds_read_b128 v[24:27], v4 offset:26624
    v_fmamk_f32 v53, v216, 0x3b124925, v7
    v_rsq_f32 v216, v53
    s_nop 0
    v_mfma_f32_32x32x16_bf16 v[80:95], a[196:199], v[36:39], v[80:95]
    v_mul_f32 v49, 0xbfb8aa3b, v216
    v_add_f32 v224, v224, v225
    v_add_f32 v226, v226, v227
    s_waitcnt lgkmcnt(4)
    v_mfma_f32_32x32x16_bf16 v[64:79], a[88:91], v[40:43], v[64:79]
    ds_read_b128 v[28:31], v4 offset:27648
    s_add_u32 s97, s97, 4096
    s_add_u32 m0, s96, 61440
    s_nop 0
    buffer_load_dwordx4 v4, s[12:15], s97 offen offset:0 sc1 lds
    v_add_f32 v228, v228, v229
    v_add_f32 v230, v230, v231
    v_add_f32 v224, v224, v226
    v_mfma_f32_32x32x16_bf16 v[80:95], a[200:203], v[40:43], v[80:95]
    v_add_f32 v228, v228, v230
    v_add_f32 v224, v224, v228
    v_mov_b32 v225, v224
    s_waitcnt lgkmcnt(4)
    v_mfma_f32_32x32x16_bf16 v[64:79], a[92:95], v[44:47], v[64:79]
    v_mov_b32 v7, 0x3727c5ac
    v_permlane32_swap_b32 v225, v224
    v_add_f32 v224, v224, v225
    v_fmamk_f32 v54, v224, 0x3b124925, v7
    v_mfma_f32_32x32x16_bf16 v[80:95], a[204:207], v[44:47], v[80:95]
    v_rsq_f32 v224, v54
    s_nop 0
    v_mul_f32 v50, 0xbfb8aa3b, v224
    s_waitcnt lgkmcnt(3)
    s_waitcnt vmcnt(20)
    v_mfma_f32_32x32x16_bf16 v[64:79], a[96:99], v[16:19], v[64:79]
    buffer_load_dwordx4 v4, s[12:15], s97 offen offset:1024 sc1 lds
    v_add_f32 v232, v232, v233
    v_add_f32 v234, v234, v235
    s_waitcnt vmcnt(20)
    v_mfma_f32_32x32x16_bf16 v[80:95], a[208:211], v[16:19], v[80:95]
    v_add_f32 v236, v236, v237
    v_add_f32 v238, v238, v239
    v_add_f32 v232, v232, v234
    v_add_f32 v236, v236, v238
    s_waitcnt lgkmcnt(2)
    s_waitcnt vmcnt(19)
    v_mfma_f32_32x32x16_bf16 v[64:79], a[100:103], v[20:23], v[64:79]
    v_add_f32 v232, v232, v236
    v_mov_b32 v233, v232
    v_mov_b32 v7, 0x3727c5ac
    s_waitcnt vmcnt(18)
    v_mfma_f32_32x32x16_bf16 v[80:95], a[212:215], v[20:23], v[80:95]
    v_permlane32_swap_b32 v233, v232
    v_add_f32 v232, v232, v233
    v_fmamk_f32 v55, v232, 0x3b124925, v7
    s_waitcnt lgkmcnt(1)
    s_waitcnt vmcnt(17)
    v_mfma_f32_32x32x16_bf16 v[64:79], a[104:107], v[24:27], v[64:79]
    buffer_load_dwordx4 v4, s[12:15], s97 offen offset:2048 sc1 lds
    v_rsq_f32 v232, v55
    s_nop 0
    v_mul_f32 v51, 0xbfb8aa3b, v232
    s_waitcnt vmcnt(17)
    v_mfma_f32_32x32x16_bf16 v[80:95], a[216:219], v[24:27], v[80:95]
    s_waitcnt lgkmcnt(0)
    s_waitcnt vmcnt(16)
    v_mfma_f32_32x32x16_bf16 v[64:79], a[108:111], v[28:31], v[64:79]
    s_waitcnt vmcnt(15)
    v_mfma_f32_32x32x16_bf16 v[80:95], a[220:223], v[28:31], v[80:95]
    s_waitcnt vmcnt(8)
    s_waitcnt vmcnt(7)
    s_mov_b32 s51, 0
Lec_38:
    v_cmp_ne_u32 vcc, s47, v9
    s_nop 4
    s_cbranch_vccz Lec_37
    buffer_load_dword v9, v11, s[12:15], s91 offen sc1
    s_waitcnt vmcnt(0)
    s_add_u32 s51, s51, 1
    s_cmp_lt_u32 s51, 100000
    s_cbranch_scc1 Lec_38
Lec_37:
    s_barrier
    ds_read_b128 v[16:19], v4 offset:28672
    ds_read_b128 v[20:23], v4 offset:29696
    ds_read_b128 v[24:27], v4 offset:30720
    ds_read_b128 v[28:31], v4 offset:31744
    ds_read_b128 v[32:35], v4 offset:32768
    s_waitcnt lgkmcnt(4)
    v_mfma_f32_32x32x16_bf16 v[96:111], a[0:3], v[16:19], 0
    ds_read_b128 v[36:39], v4 offset:33792
    s_add_u32 s97, s57, 3
    s_mul_i32 s97, s97, 28672
    s_add_u32 s97, s97, s98
    s_add_u32 s97, s97, 0x400000
    s_add_u32 m0, s96, 86016
    s_nop 0
    buffer_load_dwordx4 v4, s[12:15], s97 offen offset:0 sc1 lds
    v_mfma_f32_32x32x16_bf16 v[112:127], a[112:115], v[16:19], 0
    s_waitcnt lgkmcnt(4)
    v_mfma_f32_32x32x16_bf16 v[96:111], a[4:7], v[20:23], v[96:111]
    ds_read_b128 v[40:43], v4 offset:34816
    buffer_load_dwordx4 v4, s[12:15], s97 offen offset:1024 sc1 lds
    v_mfma_f32_32x32x16_bf16 v[112:127], a[116:119], v[20:23], v[112:127]
    v_mul_f32 v128, v64, v48
    v_mul_f32 v129, v65, v48
    v_mul_f32 v130, v66, v48
    s_waitcnt lgkmcnt(4)
    v_mfma_f32_32x32x16_bf16 v[96:111], a[8:11], v[24:27], v[96:111]
    ds_read_b128 v[44:47], v4 offset:35840
    v_mul_f32 v131, v67, v48
    v_mul_f32 v132, v68, v48
    v_mfma_f32_32x32x16_bf16 v[112:127], a[120:123], v[24:27], v[112:127]
    buffer_load_dwordx4 v4, s[12:15], s97 offen offset:2048 sc1 lds
    v_mul_f32 v133, v69, v48
    v_mul_f32 v134, v70, v48
    s_waitcnt lgkmcnt(4)
    v_mfma_f32_32x32x16_bf16 v[96:111], a[12:15], v[28:31], v[96:111]
    ds_read_b128 v[16:19], v4 offset:36864
    v_mul_f32 v135, v71, v48
    v_exp_f32 v128, v128
    v_mfma_f32_32x32x16_bf16 v[112:127], a[124:127], v[28:31], v[112:127]
    v_mul_f32 v136, v64, v72
    v_exp_f32 v129, v129
    s_waitcnt lgkmcnt(4)
    v_mfma_f32_32x32x16_bf16 v[96:111], a[16:19], v[32:35], v[96:111]
    ds_read_b128 v[20:23], v4 offset:37888
    buffer_load_dwordx4 v4, s[12:15], s97 offen offset:3072 sc1 lds
    v_mul_f32 v137, v65, v73
    v_exp_f32 v130, v130
    v_mfma_f32_32x32x16_bf16 v[112:127], a[128:131], v[32:35], v[112:127]
    v_mul_f32 v138, v66, v74
    v_exp_f32 v131, v131
    v_mul_f32 v139, v67, v75
    s_waitcnt lgkmcnt(4)
    v_mfma_f32_32x32x16_bf16 v[96:111], a[20:23], v[36:39], v[96:111]
    ds_read_b128 v[24:27], v4 offset:38912
    s_add_u32 s97, s97, 4096
    s_add_u32 m0, s96, 90112
    s_nop 0
    buffer_load_dwordx4 v4, s[12:15], s97 offen offset:0 sc1 lds
    v_exp_f32 v132, v132
    v_mul_f32 v140, v68, v76
    v_mfma_f32_32x32x16_bf16 v[112:127], a[132:135], v[36:39], v[112:127]
    v_exp_f32 v133, v133
    v_mul_f32 v141, v69, v77
    s_waitcnt lgkmcnt(4)
    v_mfma_f32_32x32x16_bf16 v[96:111], a[24:27], v[40:43], v[96:111]
    ds_read_b128 v[28:31], v4 offset:39936
    v_exp_f32 v134, v134
    v_mul_f32 v142, v70, v78
    v_mfma_f32_32x32x16_bf16 v[112:127], a[136:139], v[40:43], v[112:127]
    buffer_load_dwordx4 v4, s[12:15], s97 offen offset:1024 sc1 lds
    v_exp_f32 v135, v135
    v_mul_f32 v143, v71, v79
    s_waitcnt lgkmcnt(4)
    v_mfma_f32_32x32x16_bf16 v[96:111], a[28:31], v[44:47], v[96:111]
    ds_read_b128 v[32:35], v4 offset:40960
    v_fma_f32 v128, v128, v52, v52
    v_fma_f32 v129, v129, v52, v52
    v_mfma_f32_32x32x16_bf16 v[112:127], a[140:143], v[44:47], v[112:127]
    v_fma_f32 v130, v130, v52, v52
    v_fma_f32 v131, v131, v52, v52
    v_fma_f32 v132, v132, v52, v52
    s_waitcnt lgkmcnt(4)
    v_mfma_f32_32x32x16_bf16 v[96:111], a[32:35], v[16:19], v[96:111]
    ds_read_b128 v[36:39], v4 offset:41984
    buffer_load_dwordx4 v4, s[12:15], s97 offen offset:2048 sc1 lds
    v_fma_f32 v133, v133, v52, v52
    v_fma_f32 v134, v134, v52, v52
    v_mfma_f32_32x32x16_bf16 v[112:127], a[144:147], v[16:19], v[112:127]
    v_fma_f32 v135, v135, v52, v52
    v_rcp_f32 v128, v128
    s_waitcnt lgkmcnt(4)
    v_mfma_f32_32x32x16_bf16 v[96:111], a[36:39], v[20:23], v[96:111]
    ds_read_b128 v[40:43], v4 offset:43008
    s_mov_b32 s62, 0
    s_add_u32 s63, s61, s62
    s_add_u32 s62, s60, s62
    buffer_load_dwordx4 v[144:147], v10, s[12:15], s62 offen offset:0 sc1
    v_rcp_f32 v129, v129
    v_rcp_f32 v130, v130
    v_mfma_f32_32x32x16_bf16 v[112:127], a[148:151], v[20:23], v[112:127]
    v_rcp_f32 v131, v131
    v_rcp_f32 v132, v132
    s_waitcnt lgkmcnt(4)
    v_mfma_f32_32x32x16_bf16 v[96:111], a[40:43], v[24:27], v[96:111]
    ds_read_b128 v[44:47], v4 offset:44032
    v_rcp_f32 v133, v133
    v_rcp_f32 v134, v134
    v_mfma_f32_32x32x16_bf16 v[112:127], a[152:155], v[24:27], v[112:127]
    buffer_load_dwordx4 v[148:151], v10, s[12:15], s63 offen offset:0 sc1
    v_rcp_f32 v135, v135
    v_mul_f32 v136, v136, v128
    v_mul_f32 v137, v137, v129
    s_waitcnt lgkmcnt(4)
    v_mfma_f32_32x32x16_bf16 v[96:111], a[44:47], v[28:31], v[96:111]
    ds_read_b128 v[16:19], v4 offset:45056
    v_mul_f32 v138, v138, v130
    v_mul_f32 v139, v139, v131
    v_mfma_f32_32x32x16_bf16 v[112:127], a[156:159], v[28:31], v[112:127]
    v_mul_f32 v140, v140, v132
    v_mul_f32 v141, v141, v133
    s_waitcnt lgkmcnt(4)
    v_mfma_f32_32x32x16_bf16 v[96:111], a[48:51], v[32:35], v[96:111]
    ds_read_b128 v[20:23], v4 offset:46080
    buffer_load_dwordx4 v[152:155], v10, s[12:15], s62 offen offset:1024 sc1
    v_mul_f32 v142, v142, v134
    v_mul_f32 v143, v143, v135
    v_mfma_f32_32x32x16_bf16 v[112:127], a[160:163], v[32:35], v[112:127]
    v_cvt_pk_bf16_f32 v56, v136, v137
    v_cvt_pk_bf16_f32 v57, v138, v139
    s_waitcnt lgkmcnt(4)
    v_mfma_f32_32x32x16_bf16 v[96:111], a[52:55], v[36:39], v[96:111]
    ds_read_b128 v[24:27], v4 offset:47104
    buffer_load_dwordx4 v[156:159], v10, s[12:15], s63 offen offset:1024 sc1
    v_cvt_pk_bf16_f32 v58, v140, v141
    v_cvt_pk_bf16_f32 v59, v142, v143
    v_mfma_f32_32x32x16_bf16 v[112:127], a[164:167], v[36:39], v[112:127]
    s_add_u32 s53, s99, 0
    buffer_store_dwordx4 v[56:59], v4, s[12:15], s53 offen sc1
    s_waitcnt lgkmcnt(4)
    v_mfma_f32_32x32x16_bf16 v[96:111], a[56:59], v[40:43], v[96:111]
    ds_read_b128 v[28:31], v4 offset:48128
    v_mul_f32 v128, v80, v48
    v_mul_f32 v129, v81, v48
    v_mul_f32 v130, v82, v48
    v_mfma_f32_32x32x16_bf16 v[112:127], a[168:171], v[40:43], v[112:127]
    buffer_load_dwordx4 v[160:163], v10, s[12:15], s62 offen offset:2048 sc1
    v_mul_f32 v131, v83, v48
    v_mul_f32 v132, v84, v48
    s_waitcnt lgkmcnt(4)
    v_mfma_f32_32x32x16_bf16 v[96:111], a[60:63], v[44:47], v[96:111]
    ds_read_b128 v[32:35], v4 offset:49152
    v_mul_f32 v133, v85, v48
    v_mul_f32 v134, v86, v48
    v_mfma_f32_32x32x16_bf16 v[112:127], a[172:175], v[44:47], v[112:127]
    v_mul_f32 v135, v87, v48
    v_exp_f32 v128, v128
    s_waitcnt lgkmcnt(4)
    v_mfma_f32_32x32x16_bf16 v[96:111], a[64:67], v[16:19], v[96:111]
    ds_read_b128 v[36:39], v4 offset:50176
    buffer_load_dwordx4 v[164:167], v10, s[12:15], s63 offen offset:2048 sc1
    v_mul_f32 v136, v80, v88
    v_exp_f32 v129, v129
    v_mfma_f32_32x32x16_bf16 v[112:127], a[176:179], v[16:19], v[112:127]
    v_mul_f32 v137, v81, v89
    v_exp_f32 v130, v130
    s_waitcnt lgkmcnt(4)
    v_mfma_f32_32x32x16_bf16 v[96:111], a[68:71], v[20:23], v[96:111]
    ds_read_b128 v[40:43], v4 offset:51200
    buffer_load_dwordx4 v[168:171], v10, s[12:15], s62 offen offset:3072 sc1
    v_mul_f32 v138, v82, v90
    v_exp_f32 v131, v131
    v_mul_f32 v139, v83, v91
    v_mfma_f32_32x32x16_bf16 v[112:127], a[180:183], v[20:23], v[112:127]
    v_exp_f32 v132, v132
    v_mul_f32 v140, v84, v92
    s_waitcnt lgkmcnt(4)
    v_mfma_f32_32x32x16_bf16 v[96:111], a[72:75], v[24:27], v[96:111]
    ds_read_b128 v[44:47], v4 offset:52224
    v_exp_f32 v133, v133
    v_mul_f32 v141, v85, v93
    v_mfma_f32_32x32x16_bf16 v[112:127], a[184:187], v[24:27], v[112:127]
    buffer_load_dwordx4 v[172:175], v10, s[12:15], s63 offen offset:3072 sc1
    v_exp_f32 v134, v134
    v_mul_f32 v142, v86, v94
    s_waitcnt lgkmcnt(4)
    v_mfma_f32_32x32x16_bf16 v[96:111], a[76:79], v[28:31], v[96:111]
    ds_read_b128 v[16:19], v4 offset:53248
    v_exp_f32 v135, v135
    v_mul_f32 v143, v87, v95
    v_mfma_f32_32x32x16_bf16 v[112:127], a[188:191], v[28:31], v[112:127]
    v_fma_f32 v128, v128, v52, v52
    v_fma_f32 v129, v129, v52, v52
    s_waitcnt lgkmcnt(4)
    v_mfma_f32_32x32x16_bf16 v[96:111], a[80:83], v[32:35], v[96:111]
    ds_read_b128 v[20:23], v4 offset:54272
    s_mov_b32 s62, 4096
    s_add_u32 s63, s61, s62
    s_add_u32 s62, s60, s62
    buffer_load_dwordx4 v[176:179], v10, s[12:15], s62 offen offset:0 sc1
    v_fma_f32 v130, v130, v52, v52
    v_fma_f32 v131, v131, v52, v52
    v_fma_f32 v132, v132, v52, v52
    v_mfma_f32_32x32x16_bf16 v[112:127], a[192:195], v[32:35], v[112:127]
    v_fma_f32 v133, v133, v52, v52
    v_fma_f32 v134, v134, v52, v52
    s_waitcnt lgkmcnt(4)
    v_mfma_f32_32x32x16_bf16 v[96:111], a[84:87], v[36:39], v[96:111]
    ds_read_b128 v[24:27], v4 offset:55296
    buffer_load_dwordx4 v[180:183], v10, s[12:15], s63 offen offset:0 sc1
    v_fma_f32 v135, v135, v52, v52
    v_rcp_f32 v128, v128
    v_mfma_f32_32x32x16_bf16 v[112:127], a[196:199], v[36:39], v[112:127]
    v_rcp_f32 v129, v129
    v_rcp_f32 v130, v130
    s_waitcnt lgkmcnt(4)
    v_mfma_f32_32x32x16_bf16 v[96:111], a[88:91], v[40:43], v[96:111]
    ds_read_b128 v[28:31], v4 offset:56320
    v_rcp_f32 v131, v131
    v_rcp_f32 v132, v132
    v_mfma_f32_32x32x16_bf16 v[112:127], a[200:203], v[40:43], v[112:127]
    buffer_load_dwordx4 v[184:187], v10, s[12:15], s62 offen offset:1024 sc1
    v_rcp_f32 v133, v133
    v_rcp_f32 v134, v134
    s_waitcnt lgkmcnt(4)
    v_mfma_f32_32x32x16_bf16 v[96:111], a[92:95], v[44:47], v[96:111]
    v_rcp_f32 v135, v135
    v_mul_f32 v136, v136, v128
    v_mul_f32 v137, v137, v129
    v_mfma_f32_32x32x16_bf16 v[112:127], a[204:207], v[44:47], v[112:127]
    v_mul_f32 v138, v138, v130
    v_mul_f32 v139, v139, v131
    s_waitcnt lgkmcnt(3)
    v_mfma_f32_32x32x16_bf16 v[96:111], a[96:99], v[16:19], v[96:111]
    buffer_load_dwordx4 v[188:191], v10, s[12:15], s63 offen offset:1024 sc1
    v_mul_f32 v140, v140, v132
    v_mul_f32 v141, v141, v133
    v_mfma_f32_32x32x16_bf16 v[112:127], a[208:211], v[16:19], v[112:127]
    v_mul_f32 v142, v142, v134
    v_mul_f32 v143, v143, v135
    s_waitcnt lgkmcnt(2)
    v_mfma_f32_32x32x16_bf16 v[96:111], a[100:103], v[20:23], v[96:111]
    buffer_load_dwordx4 v[192:195], v10, s[12:15], s62 offen offset:2048 sc1
    v_cvt_pk_bf16_f32 v60, v136, v137
    v_cvt_pk_bf16_f32 v61, v138, v139
    v_mfma_f32_32x32x16_bf16 v[112:127], a[212:215], v[20:23], v[112:127]
    v_cvt_pk_bf16_f32 v62, v140, v141
    v_cvt_pk_bf16_f32 v63, v142, v143
    s_waitcnt lgkmcnt(1)
    v_mfma_f32_32x32x16_bf16 v[96:111], a[104:107], v[24:27], v[96:111]
    s_add_u32 s53, s99, 1024
    buffer_store_dwordx4 v[60:63], v4, s[12:15], s53 offen sc1
    v_mfma_f32_32x32x16_bf16 v[112:127], a[216:219], v[24:27], v[112:127]
    buffer_load_dwordx4 v[196:199], v10, s[12:15], s63 offen offset:2048 sc1
    s_waitcnt lgkmcnt(0)
    v_mfma_f32_32x32x16_bf16 v[96:111], a[108:111], v[28:31], v[96:111]
    v_mfma_f32_32x32x16_bf16 v[112:127], a[220:223], v[28:31], v[112:127]
    s_waitcnt vmcnt(23)
    s_barrier
    ds_read_b128 v[16:19], v6 offset:0
    ds_read_b128 v[20:23], v6 offset:1024
    ds_read_b128 v[24:27], v6 offset:2048
    ds_read_b128 v[28:31], v6 offset:3072
    ds_read_b128 v[32:35], v6 offset:4096
    s_waitcnt lgkmcnt(4)
    v_mfma_f32_32x32x16_bf16 v[64:79], a[0:3], v[16:19], 0
    ds_read_b128 v[36:39], v6 offset:5120
    buffer_load_dwordx4 v[200:203], v10, s[12:15], s62 offen offset:3072 sc1
    v_mfma_f32_32x32x16_bf16 v[80:95], a[112:115], v[16:19], 0
    s_waitcnt lgkmcnt(4)
    v_mfma_f32_32x32x16_bf16 v[64:79], a[4:7], v[20:23], v[64:79]
    ds_read_b128 v[40:43], v6 offset:6144
    buffer_load_dwordx4 v[204:207], v10, s[12:15], s63 offen offset:3072 sc1
    v_mfma_f32_32x32x16_bf16 v[80:95], a[116:119], v[20:23], v[80:95]
    v_mul_f32 v128, v96, v49
    v_mul_f32 v129, v97, v49
    v_mul_f32 v130, v98, v49
    s_waitcnt lgkmcnt(4)
    v_mfma_f32_32x32x16_bf16 v[64:79], a[8:11], v[24:27], v[64:79]
    ds_read_b128 v[44:47], v6 offset:7168
    v_mul_f32 v131, v99, v49
    v_mul_f32 v132, v100, v49
    v_mul_f32 v133, v101, v49
    v_mfma_f32_32x32x16_bf16 v[80:95], a[120:123], v[24:27], v[80:95]
    s_mov_b32 s62, 8192
    s_add_u32 s63, s61, s62
    s_add_u32 s62, s60, s62
    buffer_load_dwordx4 v[208:211], v10, s[12:15], s62 offen offset:0 sc1
    v_mul_f32 v134, v102, v49
    v_mul_f32 v135, v103, v49
    v_exp_f32 v128, v128
    s_waitcnt lgkmcnt(4)
    v_mfma_f32_32x32x16_bf16 v[64:79], a[12:15], v[28:31], v[64:79]
    ds_read_b128 v[16:19], v6 offset:8192
    v_mul_f32 v136, v96, v104
    v_exp_f32 v129, v129
    v_mfma_f32_32x32x16_bf16 v[80:95], a[124:127], v[28:31], v[80:95]
    v_mul_f32 v137, v97, v105
    v_exp_f32 v130, v130
    v_mul_f32 v138, v98, v106
    s_waitcnt lgkmcnt(4)
    v_mfma_f32_32x32x16_bf16 v[64:79], a[16:19], v[32:35], v[64:79]
    ds_read_b128 v[20:23], v6 offset:9216
    buffer_load_dwordx4 v[212:215], v10, s[12:15], s63 offen offset:0 sc1
    v_exp_f32 v131, v131
    v_mul_f32 v139, v99, v107
    v_exp_f32 v132, v132
    v_mfma_f32_32x32x16_bf16 v[80:95], a[128:131], v[32:35], v[80:95]
    v_mul_f32 v140, v100, v108
    v_exp_f32 v133, v133
    s_waitcnt lgkmcnt(4)
    v_mfma_f32_32x32x16_bf16 v[64:79], a[20:23], v[36:39], v[64:79]
    ds_read_b128 v[24:27], v6 offset:10240
    buffer_load_dwordx4 v[216:219], v10, s[12:15], s62 offen offset:1024 sc1
    v_mul_f32 v141, v101, v109
    v_exp_f32 v134, v134
    v_mul_f32 v142, v102, v110
    v_mfma_f32_32x32x16_bf16 v[80:95], a[132:135], v[36:39], v[80:95]
    v_exp_f32 v135, v135
    v_mul_f32 v143, v103, v111
    v_fma_f32 v128, v128, v53, v53
    s_waitcnt lgkmcnt(4)
    v_mfma_f32_32x32x16_bf16 v[64:79], a[24:27], v[40:43], v[64:79]
    ds_read_b128 v[28:31], v6 offset:11264
    v_fma_f32 v129, v129, v53, v53
    v_fma_f32 v130, v130, v53, v53
    v_mfma_f32_32x32x16_bf16 v[80:95], a[136:139], v[40:43], v[80:95]
    buffer_load_dwordx4 v[220:223], v10, s[12:15], s63 offen offset:1024 sc1
    v_fma_f32 v131, v131, v53, v53
    v_fma_f32 v132, v132, v53, v53
    v_fma_f32 v133, v133, v53, v53
    s_waitcnt lgkmcnt(4)
    v_mfma_f32_32x32x16_bf16 v[64:79], a[28:31], v[44:47], v[64:79]
    ds_read_b128 v[32:35], v6 offset:12288
    v_fma_f32 v134, v134, v53, v53
    v_fma_f32 v135, v135, v53, v53
    v_rcp_f32 v128, v128
    v_mfma_f32_32x32x16_bf16 v[80:95], a[140:143], v[44:47], v[80:95]
    v_rcp_f32 v129, v129
    v_rcp_f32 v130, v130
    v_rcp_f32 v131, v131
    s_waitcnt lgkmcnt(4)
    v_mfma_f32_32x32x16_bf16 v[64:79], a[32:35], v[16:19], v[64:79]
    ds_read_b128 v[36:39], v6 offset:13312
    buffer_load_dwordx4 v[224:227], v10, s[12:15], s62 offen offset:2048 sc1
    v_rcp_f32 v132, v132
    v_rcp_f32 v133, v133
    v_mfma_f32_32x32x16_bf16 v[80:95], a[144:147], v[16:19], v[80:95]
    v_rcp_f32 v134, v134
    v_rcp_f32 v135, v135
    v_mul_f32 v136, v136, v128
    s_waitcnt lgkmcnt(4)
    v_mfma_f32_32x32x16_bf16 v[64:79], a[36:39], v[20:23], v[64:79]
    ds_read_b128 v[40:43], v6 offset:14336
    buffer_load_dwordx4 v[228:231], v10, s[12:15], s63 offen offset:2048 sc1
    v_mul_f32 v137, v137, v129
    v_mul_f32 v138, v138, v130
    v_mul_f32 v139, v139, v131
    v_mfma_f32_32x32x16_bf16 v[80:95], a[148:151], v[20:23], v[80:95]
    v_mul_f32 v140, v140, v132
    v_mul_f32 v141, v141, v133
    s_waitcnt lgkmcnt(4)
    v_mfma_f32_32x32x16_bf16 v[64:79], a[40:43], v[24:27], v[64:79]
    ds_read_b128 v[44:47], v6 offset:15360
    v_mul_f32 v142, v142, v134
    v_mul_f32 v143, v143, v135
    v_cvt_pk_bf16_f32 v56, v136, v137
    v_mfma_f32_32x32x16_bf16 v[80:95], a[152:155], v[24:27], v[80:95]
    buffer_load_dwordx4 v[232:235], v10, s[12:15], s62 offen offset:3072 sc1
    v_cvt_pk_bf16_f32 v57, v138, v139
    v_cvt_pk_bf16_f32 v58, v140, v141
    v_cvt_pk_bf16_f32 v59, v142, v143
    s_waitcnt lgkmcnt(4)
    v_mfma_f32_32x32x16_bf16 v[64:79], a[44:47], v[28:31], v[64:79]
    ds_read_b128 v[16:19], v6 offset:16384
    s_add_u32 s53, s99, 114688
    buffer_store_dwordx4 v[56:59], v4, s[12:15], s53 offen sc1
    v_mfma_f32_32x32x16_bf16 v[80:95], a[156:159], v[28:31], v[80:95]
    v_mul_f32 v128, v112, v49
    v_mul_f32 v129, v113, v49
    v_mul_f32 v130, v114, v49
    s_waitcnt lgkmcnt(4)
    v_mfma_f32_32x32x16_bf16 v[64:79], a[48:51], v[32:35], v[64:79]
    ds_read_b128 v[20:23], v6 offset:17408
    buffer_load_dwordx4 v[236:239], v10, s[12:15], s63 offen offset:3072 sc1
    v_mul_f32 v131, v115, v49
    v_mul_f32 v132, v116, v49
    v_mul_f32 v133, v117, v49
    v_mfma_f32_32x32x16_bf16 v[80:95], a[160:163], v[32:35], v[80:95]
    v_mul_f32 v134, v118, v49
    v_mul_f32 v135, v119, v49
    v_exp_f32 v128, v128
    s_waitcnt lgkmcnt(4)
    v_mfma_f32_32x32x16_bf16 v[64:79], a[52:55], v[36:39], v[64:79]
    ds_read_b128 v[24:27], v6 offset:18432
    s_mov_b32 s62, 12288
    s_add_u32 s63, s61, s62
    s_add_u32 s62, s60, s62
    buffer_load_dwordx4 v[240:243], v10, s[12:15], s62 offen offset:0 sc1
    v_mul_f32 v136, v112, v120
    v_exp_f32 v129, v129
    v_mfma_f32_32x32x16_bf16 v[80:95], a[164:167], v[36:39], v[80:95]
    v_mul_f32 v137, v113, v121
    v_exp_f32 v130, v130
    v_mul_f32 v138, v114, v122
    s_waitcnt lgkmcnt(4)
    v_mfma_f32_32x32x16_bf16 v[64:79], a[56:59], v[40:43], v[64:79]
    ds_read_b128 v[28:31], v6 offset:19456
    v_exp_f32 v131, v131
    v_mul_f32 v139, v115, v123
    v_exp_f32 v132, v132
    v_mfma_f32_32x32x16_bf16 v[80:95], a[168:171], v[40:43], v[80:95]
    buffer_load_dwordx4 v[244:247], v10, s[12:15], s63 offen offset:0 sc1
    v_mul_f32 v140, v116, v124
    v_exp_f32 v133, v133
    s_waitcnt lgkmcnt(4)
    v_mfma_f32_32x32x16_bf16 v[64:79], a[60:63], v[44:47], v[64:79]
    ds_read_b128 v[32:35], v6 offset:20480
    v_mul_f32 v141, v117, v125
    v_exp_f32 v134, v134
    v_mul_f32 v142, v118, v126
    v_mfma_f32_32x32x16_bf16 v[80:95], a[172:175], v[44:47], v[80:95]
    v_exp_f32 v135, v135
    v_mul_f32 v143, v119, v127
    v_fma_f32 v128, v128, v53, v53
    s_waitcnt lgkmcnt(4)
    v_mfma_f32_32x32x16_bf16 v[64:79], a[64:67], v[16:19], v[64:79]
    ds_read_b128 v[36:39], v6 offset:21504
    buffer_load_dwordx4 v[248:251], v10, s[12:15], s62 offen offset:1024 sc1
    v_fma_f32 v129, v129, v53, v53
    v_fma_f32 v130, v130, v53, v53
    v_mfma_f32_32x32x16_bf16 v[80:95], a[176:179], v[16:19], v[80:95]
    v_fma_f32 v131, v131, v53, v53
    v_fma_f32 v132, v132, v53, v53
    v_fma_f32 v133, v133, v53, v53
    s_waitcnt lgkmcnt(4)
    v_mfma_f32_32x32x16_bf16 v[64:79], a[68:71], v[20:23], v[64:79]
    ds_read_b128 v[40:43], v6 offset:22528
    buffer_load_dwordx4 a[224:227], v10, s[12:15], s63 offen offset:1024 sc1
    v_fma_f32 v134, v134, v53, v53
    v_fma_f32 v135, v135, v53, v53
    v_rcp_f32 v128, v128
    v_mfma_f32_32x32x16_bf16 v[80:95], a[180:183], v[20:23], v[80:95]
    v_rcp_f32 v129, v129
    v_rcp_f32 v130, v130
    v_rcp_f32 v131, v131
    s_waitcnt lgkmcnt(4)
    v_mfma_f32_32x32x16_bf16 v[64:79], a[72:75], v[24:27], v[64:79]
    ds_read_b128 v[44:47], v6 offset:23552
    v_rcp_f32 v132, v132
    v_rcp_f32 v133, v133
    v_mfma_f32_32x32x16_bf16 v[80:95], a[184:187], v[24:27], v[80:95]
    buffer_load_dwordx4 a[228:231], v10, s[12:15], s62 offen offset:2048 sc1
    v_rcp_f32 v134, v134
    v_rcp_f32 v135, v135
    v_mul_f32 v136, v136, v128
    s_waitcnt lgkmcnt(4)
    v_mfma_f32_32x32x16_bf16 v[64:79], a[76:79], v[28:31], v[64:79]
    ds_read_b128 v[16:19], v6 offset:24576
    v_mul_f32 v137, v137, v129
    v_mul_f32 v138, v138, v130
    v_mul_f32 v139, v139, v131
    v_mfma_f32_32x32x16_bf16 v[80:95], a[188:191], v[28:31], v[80:95]
    v_mul_f32 v140, v140, v132
    v_mul_f32 v141, v141, v133
    s_waitcnt lgkmcnt(4)
    v_mfma_f32_32x32x16_bf16 v[64:79], a[80:83], v[32:35], v[64:79]
    ds_read_b128 v[20:23], v6 offset:25600
    buffer_load_dwordx4 a[232:235], v10, s[12:15], s63 offen offset:2048 sc1
    v_mul_f32 v142, v142, v134
    v_mul_f32 v143, v143, v135
    v_cvt_pk_bf16_f32 v60, v136, v137
    v_mfma_f32_32x32x16_bf16 v[80:95], a[192:195], v[32:35], v[80:95]
    v_cvt_pk_bf16_f32 v61, v138, v139
    v_cvt_pk_bf16_f32 v62, v140, v141
    v_cvt_pk_bf16_f32 v63, v142, v143
    s_waitcnt lgkmcnt(4)
    v_mfma_f32_32x32x16_bf16 v[64:79], a[84:87], v[36:39], v[64:79]
    ds_read_b128 v[24:27], v6 offset:26624
    buffer_load_dwordx4 a[236:239], v10, s[12:15], s62 offen offset:3072 sc1
    s_add_u32 s53, s99, 115712
    buffer_store_dwordx4 v[60:63], v4, s[12:15], s53 offen sc1
    v_mfma_f32_32x32x16_bf16 v[80:95], a[196:199], v[36:39], v[80:95]
    s_waitcnt lgkmcnt(4)
    v_mfma_f32_32x32x16_bf16 v[64:79], a[88:91], v[40:43], v[64:79]
    ds_read_b128 v[28:31], v6 offset:27648
    v_mfma_f32_32x32x16_bf16 v[80:95], a[200:203], v[40:43], v[80:95]
    buffer_load_dwordx4 a[240:243], v10, s[12:15], s63 offen offset:3072 sc1
    s_waitcnt lgkmcnt(4)
    v_mfma_f32_32x32x16_bf16 v[64:79], a[92:95], v[44:47], v[64:79]
    v_mfma_f32_32x32x16_bf16 v[80:95], a[204:207], v[44:47], v[80:95]
    s_waitcnt lgkmcnt(3)
    v_mfma_f32_32x32x16_bf16 v[64:79], a[96:99], v[16:19], v[64:79]
    s_mov_b32 s62, 16384
    s_add_u32 s63, s61, s62
    s_add_u32 s62, s60, s62
    buffer_load_dwordx4 a[244:247], v10, s[12:15], s62 offen offset:0 sc1
    v_mfma_f32_32x32x16_bf16 v[80:95], a[208:211], v[16:19], v[80:95]
    s_waitcnt lgkmcnt(2)
    v_mfma_f32_32x32x16_bf16 v[64:79], a[100:103], v[20:23], v[64:79]
    buffer_load_dwordx4 a[248:251], v10, s[12:15], s63 offen offset:0 sc1
    v_mfma_f32_32x32x16_bf16 v[80:95], a[212:215], v[20:23], v[80:95]
    s_waitcnt lgkmcnt(1)
    v_mfma_f32_32x32x16_bf16 v[64:79], a[104:107], v[24:27], v[64:79]
    v_mfma_f32_32x32x16_bf16 v[80:95], a[216:219], v[24:27], v[80:95]
    buffer_load_dwordx4 a[252:255], v10, s[12:15], s62 offen offset:1024 sc1
    s_waitcnt lgkmcnt(0)
    v_mfma_f32_32x32x16_bf16 v[64:79], a[108:111], v[28:31], v[64:79]
    v_mfma_f32_32x32x16_bf16 v[80:95], a[220:223], v[28:31], v[80:95]
    s_waitcnt vmcnt(39)
    s_barrier
    ds_read_b128 v[16:19], v6 offset:28672
    ds_read_b128 v[20:23], v6 offset:29696
    ds_read_b128 v[24:27], v6 offset:30720
    ds_read_b128 v[28:31], v6 offset:31744
    ds_read_b128 v[32:35], v6 offset:32768
    s_waitcnt lgkmcnt(4)
    v_mfma_f32_32x32x16_bf16 v[96:111], a[0:3], v[16:19], 0
    ds_read_b128 v[36:39], v6 offset:33792
    v_mfma_f32_32x32x16_bf16 v[112:127], a[112:115], v[16:19], 0
    s_waitcnt lgkmcnt(4)
    v_mfma_f32_32x32x16_bf16 v[96:111], a[4:7], v[20:23], v[96:111]
    ds_read_b128 v[40:43], v6 offset:34816
    buffer_load_dwordx4 a[0:3], v10, s[12:15], s63 offen offset:1024 sc1
    v_mfma_f32_32x32x16_bf16 v[112:127], a[116:119], v[20:23], v[112:127]
    v_mul_f32 v128, v64, v50
    v_mul_f32 v129, v65, v50
    v_mul_f32 v130, v66, v50
    s_waitcnt lgkmcnt(4)
    v_mfma_f32_32x32x16_bf16 v[96:111], a[8:11], v[24:27], v[96:111]
    ds_read_b128 v[44:47], v6 offset:35840
    buffer_load_dwordx4 a[112:115], v10, s[12:15], s62 offen offset:2048 sc1
    v_mul_f32 v131, v67, v50
    v_mul_f32 v132, v68, v50
    v_mfma_f32_32x32x16_bf16 v[112:127], a[120:123], v[24:27], v[112:127]
    v_mul_f32 v133, v69, v50
    v_mul_f32 v134, v70, v50
    s_waitcnt lgkmcnt(4)
    v_mfma_f32_32x32x16_bf16 v[96:111], a[12:15], v[28:31], v[96:111]
    ds_read_b128 v[16:19], v6 offset:36864
    v_mul_f32 v135, v71, v50
    v_exp_f32 v128, v128
    v_mfma_f32_32x32x16_bf16 v[112:127], a[124:127], v[28:31], v[112:127]
    buffer_load_dwordx4 a[4:7], v10, s[12:15], s63 offen offset:2048 sc1
    v_mul_f32 v136, v64, v72
    v_exp_f32 v129, v129
    s_waitcnt lgkmcnt(4)
    v_mfma_f32_32x32x16_bf16 v[96:111], a[16:19], v[32:35], v[96:111]
    ds_read_b128 v[20:23], v6 offset:37888
    v_mul_f32 v137, v65, v73
    v_exp_f32 v130, v130
    v_mfma_f32_32x32x16_bf16 v[112:127], a[128:131], v[32:35], v[112:127]
    buffer_load_dwordx4 a[116:119], v10, s[12:15], s62 offen offset:3072 sc1
    v_mul_f32 v138, v66, v74
    v_exp_f32 v131, v131
    v_mul_f32 v139, v67, v75
    s_waitcnt lgkmcnt(4)
    v_mfma_f32_32x32x16_bf16 v[96:111], a[20:23], v[36:39], v[96:111]
    ds_read_b128 v[24:27], v6 offset:38912
    v_exp_f32 v132, v132
    v_mul_f32 v140, v68, v76
    v_mfma_f32_32x32x16_bf16 v[112:127], a[132:135], v[36:39], v[112:127]
    v_exp_f32 v133, v133
    v_mul_f32 v141, v69, v77
    s_waitcnt lgkmcnt(4)
    v_mfma_f32_32x32x16_bf16 v[96:111], a[24:27], v[40:43], v[96:111]
    ds_read_b128 v[28:31], v6 offset:39936
    buffer_load_dwordx4 a[8:11], v10, s[12:15], s63 offen offset:3072 sc1
    v_exp_f32 v134, v134
    v_mul_f32 v142, v70, v78
    v_mfma_f32_32x32x16_bf16 v[112:127], a[136:139], v[40:43], v[112:127]
    v_exp_f32 v135, v135
    v_mul_f32 v143, v71, v79
    s_waitcnt lgkmcnt(4)
    v_mfma_f32_32x32x16_bf16 v[96:111], a[28:31], v[44:47], v[96:111]
    ds_read_b128 v[32:35], v6 offset:40960
    s_mov_b32 s62, 20480
    s_add_u32 s63, s61, s62
    s_add_u32 s62, s60, s62
    buffer_load_dwordx4 a[120:123], v10, s[12:15], s62 offen offset:0 sc1
    v_fma_f32 v128, v128, v54, v54
    v_fma_f32 v129, v129, v54, v54
    v_mfma_f32_32x32x16_bf16 v[112:127], a[140:143], v[44:47], v[112:127]
    s_waitcnt vmcnt(10)
    s_barrier
    s_cmp_lg_u32 s44, 0
    s_cbranch_scc1 Lflg_39
    s_lshl_b32 s52, s2, 6
    s_add_u32 s52, s52, 0x1940000
    v_mov_b32 v14, s47
    v_lshlrev_b32 v15, 14, v1
    s_mov_b64 exec, 0xff
    buffer_store_dword v14, v15, s[12:15], s52 offen sc1
    s_mov_b64 exec, -1
Lflg_39:
    v_fma_f32 v130, v130, v54, v54
    v_fma_f32 v131, v131, v54, v54
    v_fma_f32 v132, v132, v54, v54
    s_waitcnt lgkmcnt(4)
    v_mfma_f32_32x32x16_bf16 v[96:111], a[32:35], v[16:19], v[96:111]
    ds_read_b128 v[36:39], v6 offset:41984
    v_fma_f32 v133, v133, v54, v54
    v_fma_f32 v134, v134, v54, v54
    v_mfma_f32_32x32x16_bf16 v[112:127], a[144:147], v[16:19], v[112:127]
    buffer_load_dwordx4 a[12:15], v10, s[12:15], s63 offen offset:0 sc1
    v_fma_f32 v135, v135, v54, v54
    v_rcp_f32 v128, v128
    s_waitcnt lgkmcnt(4)
    v_mfma_f32_32x32x16_bf16 v[96:111], a[36:39], v[20:23], v[96:111]
    ds_read_b128 v[40:43], v6 offset:43008
    v_rcp_f32 v129, v129
    v_rcp_f32 v130, v130
    v_mfma_f32_32x32x16_bf16 v[112:127], a[148:151], v[20:23], v[112:127]
    buffer_load_dwordx4 a[124:127], v10, s[12:15], s62 offen offset:1024 sc1
    v_rcp_f32 v131, v131
    v_rcp_f32 v132, v132
    s_waitcnt lgkmcnt(4)
    v_mfma_f32_32x32x16_bf16 v[96:111], a[40:43], v[24:27], v[96:111]
    ds_read_b128 v[44:47], v6 offset:44032
    v_rcp_f32 v133, v133
    v_rcp_f32 v134, v134
    v_mfma_f32_32x32x16_bf16 v[112:127], a[152:155], v[24:27], v[112:127]
    v_rcp_f32 v135, v135
    v_mul_f32 v136, v136, v128
    v_mul_f32 v137, v137, v129
    s_waitcnt lgkmcnt(4)
    v_mfma_f32_32x32x16_bf16 v[96:111], a[44:47], v[28:31], v[96:111]
    ds_read_b128 v[16:19], v6 offset:45056
    buffer_load_dwordx4 a[16:19], v10, s[12:15], s63 offen offset:1024 sc1
    v_mul_f32 v138, v138, v130
    v_mul_f32 v139, v139, v131
    v_mfma_f32_32x32x16_bf16 v[112:127], a[156:159], v[28:31], v[112:127]
    v_mul_f32 v140, v140, v132
    v_mul_f32 v141, v141, v133
    s_waitcnt lgkmcnt(4)
    v_mfma_f32_32x32x16_bf16 v[96:111], a[48:51], v[32:35], v[96:111]
    ds_read_b128 v[20:23], v6 offset:46080
    buffer_load_dwordx4 a[128:131], v10, s[12:15], s62 offen offset:2048 sc1
    v_mul_f32 v142, v142, v134
    v_mul_f32 v143, v143, v135
    v_mfma_f32_32x32x16_bf16 v[112:127], a[160:163], v[32:35], v[112:127]
    v_cvt_pk_bf16_f32 v56, v136, v137
    v_cvt_pk_bf16_f32 v57, v138, v139
    s_waitcnt lgkmcnt(4)
    v_mfma_f32_32x32x16_bf16 v[96:111], a[52:55], v[36:39], v[96:111]
    ds_read_b128 v[24:27], v6 offset:47104
    v_cvt_pk_bf16_f32 v58, v140, v141
    v_cvt_pk_bf16_f32 v59, v142, v143
    v_mfma_f32_32x32x16_bf16 v[112:127], a[164:167], v[36:39], v[112:127]
    buffer_load_dwordx4 a[20:23], v10, s[12:15], s63 offen offset:2048 sc1
    s_add_u32 s53, s99, 229376
    buffer_store_dwordx4 v[56:59], v4, s[12:15], s53 offen sc1
    s_waitcnt lgkmcnt(4)
    v_mfma_f32_32x32x16_bf16 v[96:111], a[56:59], v[40:43], v[96:111]
    ds_read_b128 v[28:31], v6 offset:48128
    v_mul_f32 v128, v80, v50
    v_mul_f32 v129, v81, v50
    v_mul_f32 v130, v82, v50
    v_mfma_f32_32x32x16_bf16 v[112:127], a[168:171], v[40:43], v[112:127]
    buffer_load_dwordx4 a[132:135], v10, s[12:15], s62 offen offset:3072 sc1
    v_mul_f32 v131, v83, v50
    v_mul_f32 v132, v84, v50
    s_waitcnt lgkmcnt(4)
    v_mfma_f32_32x32x16_bf16 v[96:111], a[60:63], v[44:47], v[96:111]
    ds_read_b128 v[32:35], v6 offset:49152
    v_mul_f32 v133, v85, v50
    v_mul_f32 v134, v86, v50
    v_mfma_f32_32x32x16_bf16 v[112:127], a[172:175], v[44:47], v[112:127]
    v_mul_f32 v135, v87, v50
    v_exp_f32 v128, v128
    s_waitcnt lgkmcnt(4)
    v_mfma_f32_32x32x16_bf16 v[96:111], a[64:67], v[16:19], v[96:111]
    ds_read_b128 v[36:39], v6 offset:50176
    buffer_load_dwordx4 a[24:27], v10, s[12:15], s63 offen offset:3072 sc1
    v_mul_f32 v136, v80, v88
    v_exp_f32 v129, v129
    v_mfma_f32_32x32x16_bf16 v[112:127], a[176:179], v[16:19], v[112:127]
    v_mul_f32 v137, v81, v89
    v_exp_f32 v130, v130
    s_waitcnt lgkmcnt(4)
    v_mfma_f32_32x32x16_bf16 v[96:111], a[68:71], v[20:23], v[96:111]
    ds_read_b128 v[40:43], v6 offset:51200
    s_mov_b32 s62, 24576
    s_add_u32 s63, s61, s62
    s_add_u32 s62, s60, s62
    buffer_load_dwordx4 a[136:139], v10, s[12:15], s62 offen offset:0 sc1
    v_mul_f32 v138, v82, v90
    v_exp_f32 v131, v131
    v_mul_f32 v139, v83, v91
    v_mfma_f32_32x32x16_bf16 v[112:127], a[180:183], v[20:23], v[112:127]
    v_exp_f32 v132, v132
    v_mul_f32 v140, v84, v92
    s_waitcnt lgkmcnt(4)
    v_mfma_f32_32x32x16_bf16 v[96:111], a[72:75], v[24:27], v[96:111]
    ds_read_b128 v[44:47], v6 offset:52224
    v_exp_f32 v133, v133
    v_mul_f32 v141, v85, v93
    v_mfma_f32_32x32x16_bf16 v[112:127], a[184:187], v[24:27], v[112:127]
    buffer_load_dwordx4 a[28:31], v10, s[12:15], s63 offen offset:0 sc1
    v_exp_f32 v134, v134
    v_mul_f32 v142, v86, v94
    s_waitcnt lgkmcnt(4)
    v_mfma_f32_32x32x16_bf16 v[96:111], a[76:79], v[28:31], v[96:111]
    ds_read_b128 v[16:19], v6 offset:53248
    v_exp_f32 v135, v135
    v_mul_f32 v143, v87, v95
    v_mfma_f32_32x32x16_bf16 v[112:127], a[188:191], v[28:31], v[112:127]
    buffer_load_dwordx4 a[140:143], v10, s[12:15], s62 offen offset:1024 sc1
    v_fma_f32 v128, v128, v54, v54
    v_fma_f32 v129, v129, v54, v54
    s_waitcnt lgkmcnt(4)
    v_mfma_f32_32x32x16_bf16 v[96:111], a[80:83], v[32:35], v[96:111]
    ds_read_b128 v[20:23], v6 offset:54272
    v_fma_f32 v130, v130, v54, v54
    v_fma_f32 v131, v131, v54, v54
    v_fma_f32 v132, v132, v54, v54
    v_mfma_f32_32x32x16_bf16 v[112:127], a[192:195], v[32:35], v[112:127]
    v_fma_f32 v133, v133, v54, v54
    v_fma_f32 v134, v134, v54, v54
    s_waitcnt lgkmcnt(4)
    v_mfma_f32_32x32x16_bf16 v[96:111], a[84:87], v[36:39], v[96:111]
    ds_read_b128 v[24:27], v6 offset:55296
    buffer_load_dwordx4 a[32:35], v10, s[12:15], s63 offen offset:1024 sc1
    v_fma_f32 v135, v135, v54, v54
    v_rcp_f32 v128, v128
    v_mfma_f32_32x32x16_bf16 v[112:127], a[196:199], v[36:39], v[112:127]
    v_rcp_f32 v129, v129
    v_rcp_f32 v130, v130
    s_waitcnt lgkmcnt(4)
    v_mfma_f32_32x32x16_bf16 v[96:111], a[88:91], v[40:43], v[96:111]
    ds_read_b128 v[28:31], v6 offset:56320
    buffer_load_dwordx4 a[144:147], v10, s[12:15], s62 offen offset:2048 sc1
    v_rcp_f32 v131, v131
    v_rcp_f32 v132, v132
    v_mfma_f32_32x32x16_bf16 v[112:127], a[200:203], v[40:43], v[112:127]
    v_rcp_f32 v133, v133
    v_rcp_f32 v134, v134
    s_waitcnt lgkmcnt(4)
    v_mfma_f32_32x32x16_bf16 v[96:111], a[92:95], v[44:47], v[96:111]
    v_rcp_f32 v135, v135
    v_mul_f32 v136, v136, v128
    v_mul_f32 v137, v137, v129
    v_mfma_f32_32x32x16_bf16 v[112:127], a[204:207], v[44:47], v[112:127]
    buffer_load_dwordx4 a[36:39], v10, s[12:15], s63 offen offset:2048 sc1
    v_mul_f32 v138, v138, v130
    v_mul_f32 v139, v139, v131
    s_waitcnt lgkmcnt(3)
    v_mfma_f32_32x32x16_bf16 v[96:111], a[96:99], v[16:19], v[96:111]
    v_mul_f32 v140, v140, v132
    v_mul_f32 v141, v141, v133
    v_mfma_f32_32x32x16_bf16 v[112:127], a[208:211], v[16:19], v[112:127]
    buffer_load_dwordx4 a[148:151], v10, s[12:15], s62 offen offset:3072 sc1
    v_mul_f32 v142, v142, v134
    v_mul_f32 v143, v143, v135
    s_waitcnt lgkmcnt(2)
    v_mfma_f32_32x32x16_bf16 v[96:111], a[100:103], v[20:23], v[96:111]
    v_cvt_pk_bf16_f32 v60, v136, v137
    v_cvt_pk_bf16_f32 v61, v138, v139
    v_mfma_f32_32x32x16_bf16 v[112:127], a[212:215], v[20:23], v[112:127]
    buffer_load_dwordx4 a[40:43], v10, s[12:15], s63 offen offset:3072 sc1
    v_cvt_pk_bf16_f32 v62, v140, v141
    v_cvt_pk_bf16_f32 v63, v142, v143
    s_waitcnt lgkmcnt(1)
    v_mfma_f32_32x32x16_bf16 v[96:111], a[104:107], v[24:27], v[96:111]
    s_add_u32 s53, s99, 230400
    buffer_store_dwordx4 v[60:63], v4, s[12:15], s53 offen sc1
    v_mfma_f32_32x32x16_bf16 v[112:127], a[216:219], v[24:27], v[112:127]
    s_waitcnt lgkmcnt(0)
    v_mfma_f32_32x32x16_bf16 v[96:111], a[108:111], v[28:31], v[96:111]
    v_mfma_f32_32x32x16_bf16 v[112:127], a[220:223], v[28:31], v[112:127]
    s_nop 10
    v_mul_f32 v128, v96, v51
    v_mul_f32 v129, v97, v51
    v_mul_f32 v130, v98, v51
    v_mul_f32 v131, v99, v51
    v_mul_f32 v132, v100, v51
    v_mul_f32 v133, v101, v51
    v_mul_f32 v134, v102, v51
    v_mul_f32 v135, v103, v51
    v_exp_f32 v128, v128
    v_mul_f32 v136, v96, v104
    v_exp_f32 v129, v129
    v_mul_f32 v137, v97, v105
    v_exp_f32 v130, v130
    v_mul_f32 v138, v98, v106
    v_exp_f32 v131, v131
    v_mul_f32 v139, v99, v107
    v_exp_f32 v132, v132
    v_mul_f32 v140, v100, v108
    v_exp_f32 v133, v133
    v_mul_f32 v141, v101, v109
    v_exp_f32 v134, v134
    v_mul_f32 v142, v102, v110
    v_exp_f32 v135, v135
    v_mul_f32 v143, v103, v111
    v_fma_f32 v128, v128, v55, v55
    v_fma_f32 v129, v129, v55, v55
    v_fma_f32 v130, v130, v55, v55
    v_fma_f32 v131, v131, v55, v55
    v_fma_f32 v132, v132, v55, v55
    v_fma_f32 v133, v133, v55, v55
    v_fma_f32 v134, v134, v55, v55
    v_fma_f32 v135, v135, v55, v55
    v_rcp_f32 v128, v128
    v_rcp_f32 v129, v129
    v_rcp_f32 v130, v130
    v_rcp_f32 v131, v131
    v_rcp_f32 v132, v132
    v_rcp_f32 v133, v133
    v_rcp_f32 v134, v134
    v_rcp_f32 v135, v135
    v_mul_f32 v136, v136, v128
    v_mul_f32 v137, v137, v129
    v_mul_f32 v138, v138, v130
    v_mul_f32 v139, v139, v131
    v_mul_f32 v140, v140, v132
    v_mul_f32 v141, v141, v133
    v_mul_f32 v142, v142, v134
    v_mul_f32 v143, v143, v135
    v_cvt_pk_bf16_f32 v56, v136, v137
    v_cvt_pk_bf16_f32 v57, v138, v139
    v_cvt_pk_bf16_f32 v58, v140, v141
    v_cvt_pk_bf16_f32 v59, v142, v143
    s_add_u32 s53, s99, 344064
    buffer_store_dwordx4 v[56:59], v4, s[12:15], s53 offen sc1
    v_mul_f32 v128, v112, v51
    v_mul_f32 v129, v113, v51
    v_mul_f32 v130, v114, v51
    v_mul_f32 v131, v115, v51
    v_mul_f32 v132, v116, v51
    v_mul_f32 v133, v117, v51
    v_mul_f32 v134, v118, v51
    v_mul_f32 v135, v119, v51
    v_exp_f32 v128, v128
    v_mul_f32 v136, v112, v120
    v_exp_f32 v129, v129
    v_mul_f32 v137, v113, v121
    v_exp_f32 v130, v130
    v_mul_f32 v138, v114, v122
    v_exp_f32 v131, v131
    v_mul_f32 v139, v115, v123
    v_exp_f32 v132, v132
    v_mul_f32 v140, v116, v124
    v_exp_f32 v133, v133
    v_mul_f32 v141, v117, v125
    v_exp_f32 v134, v134
    v_mul_f32 v142, v118, v126
    v_exp_f32 v135, v135
    v_mul_f32 v143, v119, v127
    v_fma_f32 v128, v128, v55, v55
    v_fma_f32 v129, v129, v55, v55
    v_fma_f32 v130, v130, v55, v55
    v_fma_f32 v131, v131, v55, v55
    v_fma_f32 v132, v132, v55, v55
    v_fma_f32 v133, v133, v55, v55
    v_fma_f32 v134, v134, v55, v55
    v_fma_f32 v135, v135, v55, v55
    v_rcp_f32 v128, v128
    v_rcp_f32 v129, v129
    v_rcp_f32 v130, v130
    v_rcp_f32 v131, v131
    v_rcp_f32 v132, v132
    v_rcp_f32 v133, v133
    v_rcp_f32 v134, v134
    v_rcp_f32 v135, v135
    v_mul_f32 v136, v136, v128
    v_mul_f32 v137, v137, v129
    v_mul_f32 v138, v138, v130
    v_mul_f32 v139, v139, v131
    v_mul_f32 v140, v140, v132
    v_mul_f32 v141, v141, v133
    v_mul_f32 v142, v142, v134
    v_mul_f32 v143, v143, v135
    v_cvt_pk_bf16_f32 v60, v136, v137
    v_cvt_pk_bf16_f32 v61, v138, v139
    v_cvt_pk_bf16_f32 v62, v140, v141
    v_cvt_pk_bf16_f32 v63, v142, v143
    s_add_u32 s53, s99, 345088
    buffer_store_dwordx4 v[60:63], v4, s[12:15], s53 offen sc1
    s_cmp_ge_u32 s2, 224
    s_cbranch_scc1 Lnog2_40
    s_add_u32 s91, s48, 0x1940000
    buffer_load_dword v9, v8, s[12:15], s91 offen sc1
Lnog2_40:
    s_waitcnt vmcnt(0)
    s_barrier
    s_cmp_lg_u32 s44, 0
    s_cbranch_scc1 Lsig_42
    s_lshl_b32 s52, s2, 6
    s_add_u32 s52, s52, 0x18c0000
    v_mov_b32 v14, s47
    v_lshlrev_b32 v15, 14, v1
    s_mov_b64 exec, 0xff
    buffer_store_dword v14, v15, s[12:15], s52 offen sc1
    s_mov_b64 exec, -1
Lsig_42:
    s_cmp_ge_u32 s2, 224
    s_cbranch_scc1 L_fin
    s_mov_b32 s51, 0
Lec_44:
    v_cmp_ne_u32 vcc, s47, v9
    s_nop 4
    s_cbranch_vccz Lec_43
    buffer_load_dword v9, v8, s[12:15], s91 offen sc1
    s_waitcnt vmcnt(0)
    s_add_u32 s51, s51, 1
    s_cmp_lt_u32 s51, 100000
    s_cbranch_scc1 Lec_44
Lec_43:
    s_branch L_g2
L_g2only:
    s_cmp_ge_u32 s2, 224
    s_cbranch_scc1 L_fin
    s_cmp_lg_u32 s44, 0
    s_cbranch_scc1 Lpollskip_45
    v_add_u32 v6, 224, v1
    v_lshlrev_b32 v6, 6, v6
    v_mov_b32 v5, v6
    s_add_u32 s52, s48, 0x1880000
    s_mov_b32 s51, 0
    s_mov_b64 exec, 0xfffffff
    s_waitcnt vmcnt(0)
Lpoll_46:
    buffer_load_dword v232, v5, s[12:15], s52 offen sc1
    s_waitcnt vmcnt(0)
    v_xor_b32 v6, s47, v232
    v_cmp_ne_u32 vcc, 0, v6
    s_nop 4
    s_cbranch_vccz Lpolldone_47
    s_add_u32 s51, s51, 1
    s_cmp_lt_u32 s51, 100000
    s_cbranch_scc1 Lpoll_46
Lpolldone_47:
    s_mov_b64 exec, -1
Lpollskip_45:
    s_barrier
    s_mov_b32 s62, 0
    s_add_u32 s63, s61, s62
    s_add_u32 s62, s60, s62
    buffer_load_dwordx4 v[144:147], v10, s[12:15], s62 offen offset:0 sc1
    buffer_load_dwordx4 v[148:151], v10, s[12:15], s63 offen offset:0 sc1
    buffer_load_dwordx4 v[152:155], v10, s[12:15], s62 offen offset:1024 sc1
    buffer_load_dwordx4 v[156:159], v10, s[12:15], s63 offen offset:1024 sc1
    buffer_load_dwordx4 v[160:163], v10, s[12:15], s62 offen offset:2048 sc1
    buffer_load_dwordx4 v[164:167], v10, s[12:15], s63 offen offset:2048 sc1
    buffer_load_dwordx4 v[168:171], v10, s[12:15], s62 offen offset:3072 sc1
    buffer_load_dwordx4 v[172:175], v10, s[12:15], s63 offen offset:3072 sc1
    s_mov_b32 s62, 4096
    s_add_u32 s63, s61, s62
    s_add_u32 s62, s60, s62
    buffer_load_dwordx4 v[176:179], v10, s[12:15], s62 offen offset:0 sc1
    buffer_load_dwordx4 v[180:183], v10, s[12:15], s63 offen offset:0 sc1
    buffer_load_dwordx4 v[184:187], v10, s[12:15], s62 offen offset:1024 sc1
    buffer_load_dwordx4 v[188:191], v10, s[12:15], s63 offen offset:1024 sc1
    buffer_load_dwordx4 v[192:195], v10, s[12:15], s62 offen offset:2048 sc1
    buffer_load_dwordx4 v[196:199], v10, s[12:15], s63 offen offset:2048 sc1
    buffer_load_dwordx4 v[200:203], v10, s[12:15], s62 offen offset:3072 sc1
    buffer_load_dwordx4 v[204:207], v10, s[12:15], s63 offen offset:3072 sc1
    s_mov_b32 s62, 8192
    s_add_u32 s63, s61, s62
    s_add_u32 s62, s60, s62
    buffer_load_dwordx4 v[208:211], v10, s[12:15], s62 offen offset:0 sc1
    buffer_load_dwordx4 v[212:215], v10, s[12:15], s63 offen offset:0 sc1
    buffer_load_dwordx4 v[216:219], v10, s[12:15], s62 offen offset:1024 sc1
    buffer_load_dwordx4 v[220:223], v10, s[12:15], s63 offen offset:1024 sc1
    buffer_load_dwordx4 v[224:227], v10, s[12:15], s62 offen offset:2048 sc1
    buffer_load_dwordx4 v[228:231], v10, s[12:15], s63 offen offset:2048 sc1
    buffer_load_dwordx4 v[232:235], v10, s[12:15], s62 offen offset:3072 sc1
    buffer_load_dwordx4 v[236:239], v10, s[12:15], s63 offen offset:3072 sc1
    s_mov_b32 s62, 12288
    s_add_u32 s63, s61, s62
    s_add_u32 s62, s60, s62
    buffer_load_dwordx4 v[240:243], v10, s[12:15], s62 offen offset:0 sc1
    buffer_load_dwordx4 v[244:247], v10, s[12:15], s63 offen offset:0 sc1
    buffer_load_dwordx4 v[248:251], v10, s[12:15], s62 offen offset:1024 sc1
    buffer_load_dwordx4 a[224:227], v10, s[12:15], s63 offen offset:1024 sc1
    buffer_load_dwordx4 a[228:231], v10, s[12:15], s62 offen offset:2048 sc1
    buffer_load_dwordx4 a[232:235], v10, s[12:15], s63 offen offset:2048 sc1
    buffer_load_dwordx4 a[236:239], v10, s[12:15], s62 offen offset:3072 sc1
    buffer_load_dwordx4 a[240:243], v10, s[12:15], s63 offen offset:3072 sc1
    s_mov_b32 s62, 16384
    s_add_u32 s63, s61, s62
    s_add_u32 s62, s60, s62
    buffer_load_dwordx4 a[244:247], v10, s[12:15], s62 offen offset:0 sc1
    buffer_load_dwordx4 a[248:251], v10, s[12:15], s63 offen offset:0 sc1
    buffer_load_dwordx4 a[252:255], v10, s[12:15], s62 offen offset:1024 sc1
    buffer_load_dwordx4 a[0:3], v10, s[12:15], s63 offen offset:1024 sc1
    buffer_load_dwordx4 a[112:115], v10, s[12:15], s62 offen offset:2048 sc1
    buffer_load_dwordx4 a[4:7], v10, s[12:15], s63 offen offset:2048 sc1
    buffer_load_dwordx4 a[116:119], v10, s[12:15], s62 offen offset:3072 sc1
    buffer_load_dwordx4 a[8:11], v10, s[12:15], s63 offen offset:3072 sc1
    s_mov_b32 s62, 20480
    s_add_u32 s63, s61, s62
    s_add_u32 s62, s60, s62
    buffer_load_dwordx4 a[120:123], v10, s[12:15], s62 offen offset:0 sc1
    buffer_load_dwordx4 a[12:15], v10, s[12:15], s63 offen offset:0 sc1
    buffer_load_dwordx4 a[124:127], v10, s[12:15], s62 offen offset:1024 sc1
    buffer_load_dwordx4 a[16:19], v10, s[12:15], s63 offen offset:1024 sc1
    buffer_load_dwordx4 a[128:131], v10, s[12:15], s62 offen offset:2048 sc1
    buffer_load_dwordx4 a[20:23], v10, s[12:15], s63 offen offset:2048 sc1
    buffer_load_dwordx4 a[132:135], v10, s[12:15], s62 offen offset:3072 sc1
    buffer_load_dwordx4 a[24:27], v10, s[12:15], s63 offen offset:3072 sc1
    s_mov_b32 s62, 24576
    s_add_u32 s63, s61, s62
    s_add_u32 s62, s60, s62
    buffer_load_dwordx4 a[136:139], v10, s[12:15], s62 offen offset:0 sc1
    buffer_load_dwordx4 a[28:31], v10, s[12:15], s63 offen offset:0 sc1
    buffer_load_dwordx4 a[140:143], v10, s[12:15], s62 offen offset:1024 sc1
    buffer_load_dwordx4 a[32:35], v10, s[12:15], s63 offen offset:1024 sc1
    buffer_load_dwordx4 a[144:147], v10, s[12:15], s62 offen offset:2048 sc1
    buffer_load_dwordx4 a[36:39], v10, s[12:15], s63 offen offset:2048 sc1
    buffer_load_dwordx4 a[148:151], v10, s[12:15], s62 offen offset:3072 sc1
    buffer_load_dwordx4 a[40:43], v10, s[12:15], s63 offen offset:3072 sc1
    s_lshr_b32 s52, s58, 1
    s_lshl_b32 s52, s52, 2
    s_and_b32 s53, s58, 1
    s_add_u32 s100, s52, s53
    s_sub_u32 s101, s52, s53
    s_add_u32 s101, s101, 3
    s_mul_i32 s52, s44, 28
    s_mul_i32 s53, s100, 112
    s_add_u32 s53, s53, s52
    s_lshl_b32 s53, s53, 10
    s_add_u32 s88, s53, 0x1000000
    s_mul_i32 s53, s101, 112
    s_add_u32 s53, s53, s52
    s_lshl_b32 s53, s53, 10
    s_add_u32 s89, s53, 0x1000000
L_g2late:
    s_add_u32 s91, s48, 0x1940000
    s_mov_b32 s51, 0
Lec_49:
    buffer_load_dword v9, v8, s[12:15], s91 offen sc1
    s_waitcnt vmcnt(0)
    v_cmp_ne_u32 vcc, s47, v9
    s_nop 4
    s_cbranch_vccz Lec_48
    s_add_u32 s51, s51, 1
    s_cmp_lt_u32 s51, 100000
    s_cbranch_scc1 Lec_49
Lec_48:
L_g2:
    s_add_u32 s90, s88, 0
    buffer_load_dwordx4 v[64:67], v4, s[12:15], s90 offen offset:0 sc1
    buffer_load_dwordx4 v[68:71], v4, s[12:15], s90 offen offset:1024 sc1
    buffer_load_dwordx4 v[72:75], v4, s[12:15], s90 offen offset:2048 sc1
    buffer_load_dwordx4 v[76:79], v4, s[12:15], s90 offen offset:3072 sc1
    s_add_u32 s90, s88, 4096
    buffer_load_dwordx4 v[80:83], v4, s[12:15], s90 offen offset:0 sc1
    buffer_load_dwordx4 v[84:87], v4, s[12:15], s90 offen offset:1024 sc1
    buffer_load_dwordx4 v[88:91], v4, s[12:15], s90 offen offset:2048 sc1
    buffer_load_dwordx4 v[92:95], v4, s[12:15], s90 offen offset:3072 sc1
    s_and_b32 s60, s44, 1
    s_lshl_b32 s53, s59, 1
    s_add_u32 s60, s60, s53
    s_lshr_b32 s61, s44, 1
    s_xor_b32 s52, s44, 1
    s_mul_i32 s52, s52, 6144
    v_add_u32 v11, s52, v4
    s_xor_b32 s52, s44, 2
    s_mul_i32 s52, s52, 6144
    v_add_u32 v12, s52, v4
    s_xor_b32 s52, s44, 3
    s_mul_i32 s52, s52, 6144
    v_add_u32 v13, s52, v4
    s_mul_i32 s52, s44, 6144
    v_add_u32 v133, s52, v4
    v_and_b32 v5, 31, v1
    v_mul_u32_u24 v5, 57344, v5
    v_lshrrev_b32 v6, 5, v1
    v_mul_u32_u24 v6, 448, v6
    v_add_u32 v132, v5, v6
    s_mov_b32 s87, 0xffff0000
    s_mul_i32 s52, s100, 28
    s_lshl_b32 s53, s60, 1
    s_add_u32 s52, s52, s53
    s_add_u32 s52, s52, s61
    s_lshl_b32 s52, s52, 10
    s_add_u32 s52, s52, 0x600000
    buffer_load_dwordx4 v[140:143], v4, s[12:15], s52 offen sc1
    s_waitcnt vmcnt(8)
    v_mfma_f32_32x32x16_bf16 v[16:31], v[144:147], v[64:67], 0
    v_mfma_f32_32x32x16_bf16 v[32:47], v[148:151], v[64:67], 0
    s_add_u32 s90, s88, 8192
    buffer_load_dwordx4 v[64:67], v4, s[12:15], s90 offen offset:0 sc1
    s_waitcnt vmcnt(8)
    v_mfma_f32_32x32x16_bf16 v[16:31], v[152:155], v[68:71], v[16:31]
    v_mfma_f32_32x32x16_bf16 v[32:47], v[156:159], v[68:71], v[32:47]
    buffer_load_dwordx4 v[68:71], v4, s[12:15], s90 offen offset:1024 sc1
    s_waitcnt vmcnt(8)
    v_mfma_f32_32x32x16_bf16 v[16:31], v[160:163], v[72:75], v[16:31]
    v_mfma_f32_32x32x16_bf16 v[32:47], v[164:167], v[72:75], v[32:47]
    buffer_load_dwordx4 v[72:75], v4, s[12:15], s90 offen offset:2048 sc1
    s_waitcnt vmcnt(8)
    v_mfma_f32_32x32x16_bf16 v[16:31], v[168:171], v[76:79], v[16:31]
    v_mfma_f32_32x32x16_bf16 v[32:47], v[172:175], v[76:79], v[32:47]
    buffer_load_dwordx4 v[76:79], v4, s[12:15], s90 offen offset:3072 sc1
    s_waitcnt vmcnt(8)
    v_mfma_f32_32x32x16_bf16 v[16:31], v[176:179], v[80:83], v[16:31]
    v_mfma_f32_32x32x16_bf16 v[32:47], v[180:183], v[80:83], v[32:47]
    s_add_u32 s90, s88, 12288
    buffer_load_dwordx4 v[80:83], v4, s[12:15], s90 offen offset:0 sc1
    s_waitcnt vmcnt(8)
    v_mfma_f32_32x32x16_bf16 v[16:31], v[184:187], v[84:87], v[16:31]
    v_mfma_f32_32x32x16_bf16 v[32:47], v[188:191], v[84:87], v[32:47]
    buffer_load_dwordx4 v[84:87], v4, s[12:15], s90 offen offset:1024 sc1
    s_waitcnt vmcnt(8)
    v_mfma_f32_32x32x16_bf16 v[16:31], v[192:195], v[88:91], v[16:31]
    v_mfma_f32_32x32x16_bf16 v[32:47], v[196:199], v[88:91], v[32:47]
    buffer_load_dwordx4 v[88:91], v4, s[12:15], s90 offen offset:2048 sc1
    s_waitcnt vmcnt(8)
    v_mfma_f32_32x32x16_bf16 v[16:31], v[200:203], v[92:95], v[16:31]
    v_mfma_f32_32x32x16_bf16 v[32:47], v[204:207], v[92:95], v[32:47]
    buffer_load_dwordx4 v[92:95], v4, s[12:15], s90 offen offset:3072 sc1
    s_waitcnt vmcnt(7)
    v_mfma_f32_32x32x16_bf16 v[16:31], v[208:211], v[64:67], v[16:31]
    v_mfma_f32_32x32x16_bf16 v[32:47], v[212:215], v[64:67], v[32:47]
    s_add_u32 s91, s48, 0x18c0000
    buffer_load_dword v9, v8, s[12:15], s91 offen sc1
    s_add_u32 s90, s88, 16384
    buffer_load_dwordx4 v[64:67], v4, s[12:15], s90 offen offset:0 sc1
    s_waitcnt vmcnt(8)
    v_mfma_f32_32x32x16_bf16 v[16:31], v[216:219], v[68:71], v[16:31]
    v_mfma_f32_32x32x16_bf16 v[32:47], v[220:223], v[68:71], v[32:47]
    buffer_load_dwordx4 v[68:71], v4, s[12:15], s90 offen offset:1024 sc1
    s_waitcnt vmcnt(8)
    v_mfma_f32_32x32x16_bf16 v[16:31], v[224:227], v[72:75], v[16:31]
    v_mfma_f32_32x32x16_bf16 v[32:47], v[228:231], v[72:75], v[32:47]
    buffer_load_dwordx4 v[72:75], v4, s[12:15], s90 offen offset:2048 sc1
    s_waitcnt vmcnt(8)
    v_mfma_f32_32x32x16_bf16 v[16:31], v[232:235], v[76:79], v[16:31]
    v_mfma_f32_32x32x16_bf16 v[32:47], v[236:239], v[76:79], v[32:47]
    buffer_load_dwordx4 v[76:79], v4, s[12:15], s90 offen offset:3072 sc1
    s_waitcnt vmcnt(8)
    v_mfma_f32_32x32x16_bf16 v[16:31], v[240:243], v[80:83], v[16:31]
    v_mfma_f32_32x32x16_bf16 v[32:47], v[244:247], v[80:83], v[32:47]
    s_add_u32 s90, s88, 20480
    buffer_load_dwordx4 v[80:83], v4, s[12:15], s90 offen offset:0 sc1
    s_waitcnt vmcnt(8)
    v_mfma_f32_32x32x16_bf16 v[16:31], v[248:251], v[84:87], v[16:31]
    v_mfma_f32_32x32x16_bf16 v[32:47], a[224:227], v[84:87], v[32:47]
    buffer_load_dwordx4 v[84:87], v4, s[12:15], s90 offen offset:1024 sc1
    s_waitcnt vmcnt(8)
    v_mfma_f32_32x32x16_bf16 v[16:31], a[228:231], v[88:91], v[16:31]
    v_mfma_f32_32x32x16_bf16 v[32:47], a[232:235], v[88:91], v[32:47]
    buffer_load_dwordx4 v[88:91], v4, s[12:15], s90 offen offset:2048 sc1
    s_waitcnt vmcnt(8)
    v_mfma_f32_32x32x16_bf16 v[16:31], a[236:239], v[92:95], v[16:31]
    v_mfma_f32_32x32x16_bf16 v[32:47], a[240:243], v[92:95], v[32:47]
    buffer_load_dwordx4 v[92:95], v4, s[12:15], s90 offen offset:3072 sc1
    s_waitcnt vmcnt(7)
    v_mfma_f32_32x32x16_bf16 v[16:31], a[244:247], v[64:67], v[16:31]
    v_mfma_f32_32x32x16_bf16 v[32:47], a[248:251], v[64:67], v[32:47]
    s_add_u32 s90, s88, 24576
    buffer_load_dwordx4 v[64:67], v4, s[12:15], s90 offen offset:0 sc1
    s_waitcnt vmcnt(7)
    v_mfma_f32_32x32x16_bf16 v[16:31], a[252:255], v[68:71], v[16:31]
    v_mfma_f32_32x32x16_bf16 v[32:47], a[0:3], v[68:71], v[32:47]
    buffer_load_dwordx4 v[68:71], v4, s[12:15], s90 offen offset:1024 sc1
    s_waitcnt vmcnt(7)
    v_mfma_f32_32x32x16_bf16 v[16:31], a[112:115], v[72:75], v[16:31]
    v_mfma_f32_32x32x16_bf16 v[32:47], a[4:7], v[72:75], v[32:47]
    buffer_load_dwordx4 v[72:75], v4, s[12:15], s90 offen offset:2048 sc1
    s_waitcnt vmcnt(7)
    v_mfma_f32_32x32x16_bf16 v[16:31], a[116:119], v[76:79], v[16:31]
    v_mfma_f32_32x32x16_bf16 v[32:47], a[8:11], v[76:79], v[32:47]
    buffer_load_dwordx4 v[76:79], v4, s[12:15], s90 offen offset:3072 sc1
    s_waitcnt vmcnt(7)
    v_mfma_f32_32x32x16_bf16 v[16:31], a[120:123], v[80:83], v[16:31]
    v_mfma_f32_32x32x16_bf16 v[32:47], a[12:15], v[80:83], v[32:47]
    s_mov_b32 s51, 0
Lec_51:
    v_cmp_ne_u32 vcc, s47, v9
    s_nop 4
    s_cbranch_vccz Lec_50
    buffer_load_dword v9, v8, s[12:15], s91 offen sc1
    s_waitcnt vmcnt(0)
    s_add_u32 s51, s51, 1
    s_cmp_lt_u32 s51, 100000
    s_cbranch_scc1 Lec_51
Lec_50:
    s_add_u32 s90, s89, 0
    buffer_load_dwordx4 v[80:83], v4, s[12:15], s90 offen offset:0 sc1
    s_waitcnt vmcnt(7)
    v_mfma_f32_32x32x16_bf16 v[16:31], a[124:127], v[84:87], v[16:31]
    v_mfma_f32_32x32x16_bf16 v[32:47], a[16:19], v[84:87], v[32:47]
    buffer_load_dwordx4 v[84:87], v4, s[12:15], s90 offen offset:1024 sc1
    s_waitcnt vmcnt(7)
    v_mfma_f32_32x32x16_bf16 v[16:31], a[128:131], v[88:91], v[16:31]
    v_mfma_f32_32x32x16_bf16 v[32:47], a[20:23], v[88:91], v[32:47]
    buffer_load_dwordx4 v[88:91], v4, s[12:15], s90 offen offset:2048 sc1
    s_waitcnt vmcnt(7)
    v_mfma_f32_32x32x16_bf16 v[16:31], a[132:135], v[92:95], v[16:31]
    v_mfma_f32_32x32x16_bf16 v[32:47], a[24:27], v[92:95], v[32:47]
    buffer_load_dwordx4 v[92:95], v4, s[12:15], s90 offen offset:3072 sc1
    s_waitcnt vmcnt(7)
    v_mfma_f32_32x32x16_bf16 v[16:31], a[136:139], v[64:67], v[16:31]
    v_mfma_f32_32x32x16_bf16 v[32:47], a[28:31], v[64:67], v[32:47]
    s_add_u32 s90, s89, 4096
    buffer_load_dwordx4 v[64:67], v4, s[12:15], s90 offen offset:0 sc1
    s_waitcnt vmcnt(7)
    v_mfma_f32_32x32x16_bf16 v[16:31], a[140:143], v[68:71], v[16:31]
    v_mfma_f32_32x32x16_bf16 v[32:47], a[32:35], v[68:71], v[32:47]
    buffer_load_dwordx4 v[68:71], v4, s[12:15], s90 offen offset:1024 sc1
    s_waitcnt vmcnt(7)
    v_mfma_f32_32x32x16_bf16 v[16:31], a[144:147], v[72:75], v[16:31]
    v_mfma_f32_32x32x16_bf16 v[32:47], a[36:39], v[72:75], v[32:47]
    buffer_load_dwordx4 v[72:75], v4, s[12:15], s90 offen offset:2048 sc1
    s_waitcnt vmcnt(7)
    v_mfma_f32_32x32x16_bf16 v[16:31], a[148:151], v[76:79], v[16:31]
    v_mfma_f32_32x32x16_bf16 v[32:47], a[40:43], v[76:79], v[32:47]
    buffer_load_dwordx4 v[76:79], v4, s[12:15], s90 offen offset:3072 sc1
    s_waitcnt vmcnt(7)
    v_mfma_f32_32x32x16_bf16 a[80:95], v[144:147], v[80:83], 0
    v_mfma_f32_32x32x16_bf16 a[96:111], v[148:151], v[80:83], 0
    s_add_u32 s90, s89, 8192
    buffer_load_dwordx4 v[80:83], v4, s[12:15], s90 offen offset:0 sc1
    s_mul_i32 s52, s101, 28
    s_lshl_b32 s53, s60, 1
    s_add_u32 s52, s52, s53
    s_add_u32 s52, s52, s61
    s_lshl_b32 s52, s52, 10
    s_add_u32 s52, s52, 0x600000
    buffer_load_dwordx4 v[136:139], v4, s[12:15], s52 offen sc1
    s_waitcnt vmcnt(8)
    v_mfma_f32_32x32x16_bf16 a[80:95], v[152:155], v[84:87], a[80:95]
    v_mfma_f32_32x32x16_bf16 a[96:111], v[156:159], v[84:87], a[96:111]
    buffer_load_dwordx4 v[84:87], v4, s[12:15], s90 offen offset:1024 sc1
    ds_write_b128 v11, v[32:35] offset:0
    ds_write_b128 v11, v[36:39] offset:1024
    ds_write_b128 v12, v[24:27] offset:2048
    ds_write_b128 v12, v[28:31] offset:3072
    s_waitcnt vmcnt(8)
    v_mfma_f32_32x32x16_bf16 a[80:95], v[160:163], v[88:91], a[80:95]
    v_mfma_f32_32x32x16_bf16 a[96:111], v[164:167], v[88:91], a[96:111]
    buffer_load_dwordx4 v[88:91], v4, s[12:15], s90 offen offset:2048 sc1
    ds_write_b128 v13, v[40:43] offset:4096
    ds_write_b128 v13, v[44:47] offset:5120
    s_waitcnt lgkmcnt(0)
    s_waitcnt vmcnt(8)
    v_mfma_f32_32x32x16_bf16 a[80:95], v[168:171], v[92:95], a[80:95]
    v_mfma_f32_32x32x16_bf16 a[96:111], v[172:175], v[92:95], a[96:111]
    buffer_load_dwordx4 v[92:95], v4, s[12:15], s90 offen offset:3072 sc1
    s_barrier
    ds_read_b128 v[96:99], v133 offset:0
    ds_read_b128 v[100:103], v133 offset:1024
    s_waitcnt vmcnt(8)
    v_mfma_f32_32x32x16_bf16 a[80:95], v[176:179], v[64:67], a[80:95]
    v_mfma_f32_32x32x16_bf16 a[96:111], v[180:183], v[64:67], a[96:111]
    s_add_u32 s90, s89, 12288
    buffer_load_dwordx4 v[64:67], v4, s[12:15], s90 offen offset:0 sc1
    ds_read_b128 v[104:107], v133 offset:2048
    ds_read_b128 v[108:111], v133 offset:3072
    ds_read_b128 v[112:115], v133 offset:4096
    ds_read_b128 v[116:119], v133 offset:5120
    s_waitcnt vmcnt(8)
    v_mfma_f32_32x32x16_bf16 a[80:95], v[184:187], v[68:71], a[80:95]
    v_mfma_f32_32x32x16_bf16 a[96:111], v[188:191], v[68:71], a[96:111]
    buffer_load_dwordx4 v[68:71], v4, s[12:15], s90 offen offset:1024 sc1
    s_waitcnt lgkmcnt(0)
    v_add_f32 v96, v96, v104
    v_add_f32 v112, v112, v16
    s_waitcnt vmcnt(8)
    v_mfma_f32_32x32x16_bf16 a[80:95], v[192:195], v[72:75], a[80:95]
    v_mfma_f32_32x32x16_bf16 a[96:111], v[196:199], v[72:75], a[96:111]
    buffer_load_dwordx4 v[72:75], v4, s[12:15], s90 offen offset:2048 sc1
    v_add_f32 v97, v97, v105
    v_add_f32 v113, v113, v17
    v_add_f32 v98, v98, v106
    s_waitcnt vmcnt(8)
    v_mfma_f32_32x32x16_bf16 a[80:95], v[200:203], v[76:79], a[80:95]
    v_mfma_f32_32x32x16_bf16 a[96:111], v[204:207], v[76:79], a[96:111]
    buffer_load_dwordx4 v[76:79], v4, s[12:15], s90 offen offset:3072 sc1
    v_add_f32 v114, v114, v18
    v_add_f32 v99, v99, v107
    v_add_f32 v115, v115, v19
    v_add_f32 v100, v100, v108
    s_waitcnt vmcnt(8)
    v_mfma_f32_32x32x16_bf16 a[80:95], v[208:211], v[80:83], a[80:95]
    v_mfma_f32_32x32x16_bf16 a[96:111], v[212:215], v[80:83], a[96:111]
    s_add_u32 s90, s89, 16384
    buffer_load_dwordx4 v[80:83], v4, s[12:15], s90 offen offset:0 sc1
    v_add_f32 v116, v116, v20
    v_add_f32 v101, v101, v109
    v_add_f32 v117, v117, v21
    s_waitcnt vmcnt(7)
    v_mfma_f32_32x32x16_bf16 a[80:95], v[216:219], v[84:87], a[80:95]
    v_mfma_f32_32x32x16_bf16 a[96:111], v[220:223], v[84:87], a[96:111]
    buffer_load_dwordx4 v[84:87], v4, s[12:15], s90 offen offset:1024 sc1
    v_add_f32 v102, v102, v110
    v_add_f32 v118, v118, v22
    v_add_f32 v103, v103, v111
    s_waitcnt vmcnt(7)
    v_mfma_f32_32x32x16_bf16 a[80:95], v[224:227], v[88:91], a[80:95]
    v_mfma_f32_32x32x16_bf16 a[96:111], v[228:231], v[88:91], a[96:111]
    buffer_load_dwordx4 v[88:91], v4, s[12:15], s90 offen offset:2048 sc1
    v_add_f32 v119, v119, v23
    v_add_f32 v96, v96, v112
    v_add_f32 v97, v97, v113
    v_add_f32 v98, v98, v114
    s_waitcnt vmcnt(7)
    v_mfma_f32_32x32x16_bf16 a[80:95], v[232:235], v[92:95], a[80:95]
    v_mfma_f32_32x32x16_bf16 a[96:111], v[236:239], v[92:95], a[96:111]
    buffer_load_dwordx4 v[92:95], v4, s[12:15], s90 offen offset:3072 sc1
    v_add_f32 v99, v99, v115
    v_add_f32 v100, v100, v116
    v_add_f32 v101, v101, v117
    s_waitcnt vmcnt(7)
    v_mfma_f32_32x32x16_bf16 a[80:95], v[240:243], v[64:67], a[80:95]
    v_mfma_f32_32x32x16_bf16 a[96:111], v[244:247], v[64:67], a[96:111]
    s_add_u32 s90, s89, 20480
    buffer_load_dwordx4 v[64:67], v4, s[12:15], s90 offen offset:0 sc1
    v_add_f32 v102, v102, v118
    v_add_f32 v103, v103, v119
    s_waitcnt vmcnt(7)
    v_mfma_f32_32x32x16_bf16 a[80:95], v[248:251], v[68:71], a[80:95]
    v_mfma_f32_32x32x16_bf16 a[96:111], a[224:227], v[68:71], a[96:111]
    buffer_load_dwordx4 v[68:71], v4, s[12:15], s90 offen offset:1024 sc1
    v_cvt_pk_bf16_f32 v120, v96, v97
    v_cvt_pk_bf16_f32 v121, v98, v99
    v_cvt_pk_bf16_f32 v122, v100, v101
    v_cvt_pk_bf16_f32 v123, v102, v103
    s_waitcnt vmcnt(7)
    v_mfma_f32_32x32x16_bf16 a[80:95], a[228:231], v[72:75], a[80:95]
    v_mfma_f32_32x32x16_bf16 a[96:111], a[232:235], v[72:75], a[96:111]
    buffer_load_dwordx4 v[72:75], v4, s[12:15], s90 offen offset:2048 sc1
    v_lshlrev_b32 v128, 16, v120
    v_and_b32 v129, s87, v120
    v_lshlrev_b32 v130, 16, v140
    s_waitcnt vmcnt(7)
    v_mfma_f32_32x32x16_bf16 a[80:95], a[236:239], v[76:79], a[80:95]
    v_mfma_f32_32x32x16_bf16 a[96:111], a[240:243], v[76:79], a[96:111]
    buffer_load_dwordx4 v[76:79], v4, s[12:15], s90 offen offset:3072 sc1
    v_and_b32 v131, s87, v140
    v_add_f32 v128, v128, v130
    v_add_f32 v129, v129, v131
    s_waitcnt vmcnt(7)
    v_mfma_f32_32x32x16_bf16 a[80:95], a[244:247], v[80:83], a[80:95]
    v_mfma_f32_32x32x16_bf16 a[96:111], a[248:251], v[80:83], a[96:111]
    s_add_u32 s90, s89, 24576
    buffer_load_dwordx4 v[80:83], v4, s[12:15], s90 offen offset:0 sc1
    v_cvt_pk_bf16_f32 v124, v128, v129
    v_lshlrev_b32 v128, 16, v121
    v_and_b32 v129, s87, v121
    v_lshlrev_b32 v130, 16, v141
    s_waitcnt vmcnt(7)
    v_mfma_f32_32x32x16_bf16 a[80:95], a[252:255], v[84:87], a[80:95]
    v_mfma_f32_32x32x16_bf16 a[96:111], a[0:3], v[84:87], a[96:111]
    buffer_load_dwordx4 v[84:87], v4, s[12:15], s90 offen offset:1024 sc1
    v_and_b32 v131, s87, v141
    v_add_f32 v128, v128, v130
    v_add_f32 v129, v129, v131
    s_waitcnt vmcnt(7)
    v_mfma_f32_32x32x16_bf16 a[80:95], a[112:115], v[88:91], a[80:95]
    v_mfma_f32_32x32x16_bf16 a[96:111], a[4:7], v[88:91], a[96:111]
    buffer_load_dwordx4 v[88:91], v4, s[12:15], s90 offen offset:2048 sc1
    v_cvt_pk_bf16_f32 v125, v128, v129
    v_lshlrev_b32 v128, 16, v122
    v_and_b32 v129, s87, v122
    s_waitcnt vmcnt(7)
    v_mfma_f32_32x32x16_bf16 a[80:95], a[116:119], v[92:95], a[80:95]
    v_mfma_f32_32x32x16_bf16 a[96:111], a[8:11], v[92:95], a[96:111]
    buffer_load_dwordx4 v[92:95], v4, s[12:15], s90 offen offset:3072 sc1
    v_lshlrev_b32 v130, 16, v142
    v_and_b32 v131, s87, v142
    v_add_f32 v128, v128, v130
    v_add_f32 v129, v129, v131
    s_waitcnt vmcnt(7)
    v_mfma_f32_32x32x16_bf16 a[80:95], a[120:123], v[64:67], a[80:95]
    v_mfma_f32_32x32x16_bf16 a[96:111], a[12:15], v[64:67], a[96:111]
    v_cvt_pk_bf16_f32 v126, v128, v129
    v_lshlrev_b32 v128, 16, v123
    v_and_b32 v129, s87, v123
    s_waitcnt vmcnt(6)
    v_mfma_f32_32x32x16_bf16 a[80:95], a[124:127], v[68:71], a[80:95]
    v_mfma_f32_32x32x16_bf16 a[96:111], a[16:19], v[68:71], a[96:111]
    v_lshlrev_b32 v130, 16, v143
    v_and_b32 v131, s87, v143
    v_add_f32 v128, v128, v130
    s_waitcnt vmcnt(5)
    v_mfma_f32_32x32x16_bf16 a[80:95], a[128:131], v[72:75], a[80:95]
    v_mfma_f32_32x32x16_bf16 a[96:111], a[20:23], v[72:75], a[96:111]
    v_add_f32 v129, v129, v131
    v_cvt_pk_bf16_f32 v127, v128, v129
    v_permlane32_swap_b32 v124, v126
    s_nop 0
    v_permlane32_swap_b32 v125, v127
    s_waitcnt vmcnt(4)
    v_mfma_f32_32x32x16_bf16 a[80:95], a[132:135], v[76:79], a[80:95]
    v_mfma_f32_32x32x16_bf16 a[96:111], a[24:27], v[76:79], a[96:111]
    s_lshl_b32 s52, s60, 5
    s_lshl_b32 s53, s61, 4
    s_add_u32 s52, s52, s53
    s_waitcnt vmcnt(3)
    v_mfma_f32_32x32x16_bf16 a[80:95], a[136:139], v[80:83], a[80:95]
    v_mfma_f32_32x32x16_bf16 a[96:111], a[28:31], v[80:83], a[96:111]
    s_mul_i32 s53, s100, 896
    s_add_u32 s52, s52, s53
    buffer_store_dwordx4 v[124:127], v132, s[36:39], s52 offen
    s_waitcnt vmcnt(3)
    v_mfma_f32_32x32x16_bf16 a[80:95], a[140:143], v[84:87], a[80:95]
    v_mfma_f32_32x32x16_bf16 a[96:111], a[32:35], v[84:87], a[96:111]
    s_waitcnt vmcnt(2)
    v_mfma_f32_32x32x16_bf16 a[80:95], a[144:147], v[88:91], a[80:95]
    v_mfma_f32_32x32x16_bf16 a[96:111], a[36:39], v[88:91], a[96:111]
    s_waitcnt vmcnt(1)
    v_mfma_f32_32x32x16_bf16 a[80:95], a[148:151], v[92:95], a[80:95]
    v_mfma_f32_32x32x16_bf16 a[96:111], a[40:43], v[92:95], a[96:111]
    s_nop 11
    ds_write_b128 v11, a[96:99] offset:24576
    ds_write_b128 v11, a[100:103] offset:25600
    ds_write_b128 v12, a[88:91] offset:26624
    ds_write_b128 v12, a[92:95] offset:27648
    ds_write_b128 v13, a[104:107] offset:28672
    ds_write_b128 v13, a[108:111] offset:29696
    s_waitcnt lgkmcnt(0)
    s_barrier
    ds_read_b128 v[96:99], v133 offset:24576
    ds_read_b128 v[100:103], v133 offset:25600
    ds_read_b128 v[104:107], v133 offset:26624
    ds_read_b128 v[108:111], v133 offset:27648
    ds_read_b128 v[112:115], v133 offset:28672
    ds_read_b128 v[116:119], v133 offset:29696
    v_accvgpr_read_b32 v16, a80
    v_accvgpr_read_b32 v17, a81
    v_accvgpr_read_b32 v18, a82
    v_accvgpr_read_b32 v19, a83
    v_accvgpr_read_b32 v20, a84
    v_accvgpr_read_b32 v21, a85
    v_accvgpr_read_b32 v22, a86
    v_accvgpr_read_b32 v23, a87
    s_waitcnt lgkmcnt(0)
    v_add_f32 v96, v96, v104
    v_add_f32 v112, v112, v16
    v_add_f32 v97, v97, v105
    v_add_f32 v113, v113, v17
    v_add_f32 v98, v98, v106
    v_add_f32 v114, v114, v18
    v_add_f32 v99, v99, v107
    v_add_f32 v115, v115, v19
    v_add_f32 v100, v100, v108
    v_add_f32 v116, v116, v20
    v_add_f32 v101, v101, v109
    v_add_f32 v117, v117, v21
    v_add_f32 v102, v102, v110
    v_add_f32 v118, v118, v22
    v_add_f32 v103, v103, v111
    v_add_f32 v119, v119, v23
    v_add_f32 v96, v96, v112
    v_add_f32 v97, v97, v113
    v_add_f32 v98, v98, v114
    v_add_f32 v99, v99, v115
    v_add_f32 v100, v100, v116
    v_add_f32 v101, v101, v117
    v_add_f32 v102, v102, v118
    v_add_f32 v103, v103, v119
    v_cvt_pk_bf16_f32 v120, v96, v97
    v_cvt_pk_bf16_f32 v121, v98, v99
    v_cvt_pk_bf16_f32 v122, v100, v101
    v_cvt_pk_bf16_f32 v123, v102, v103
    v_lshlrev_b32 v128, 16, v120
    v_and_b32 v129, s87, v120
    v_lshlrev_b32 v130, 16, v136
    v_and_b32 v131, s87, v136
    v_add_f32 v128, v128, v130
    v_add_f32 v129, v129, v131
    v_cvt_pk_bf16_f32 v124, v128, v129
    v_lshlrev_b32 v128, 16, v121
    v_and_b32 v129, s87, v121
    v_lshlrev_b32 v130, 16, v137
    v_and_b32 v131, s87, v137
    v_add_f32 v128, v128, v130
    v_add_f32 v129, v129, v131
    v_cvt_pk_bf16_f32 v125, v128, v129
    v_lshlrev_b32 v128, 16, v122
    v_and_b32 v129, s87, v122
    v_lshlrev_b32 v130, 16, v138
    v_and_b32 v131, s87, v138
    v_add_f32 v128, v128, v130
    v_add_f32 v129, v129, v131
    v_cvt_pk_bf16_f32 v126, v128, v129
    v_lshlrev_b32 v128, 16, v123
    v_and_b32 v129, s87, v123
    v_lshlrev_b32 v130, 16, v139
    v_and_b32 v131, s87, v139
    v_add_f32 v128, v128, v130
    v_add_f32 v129, v129, v131
    v_cvt_pk_bf16_f32 v127, v128, v129
    v_permlane32_swap_b32 v124, v126
    s_nop 0
    v_permlane32_swap_b32 v125, v127
    s_lshl_b32 s52, s60, 5
    s_lshl_b32 s53, s61, 4
    s_add_u32 s52, s52, s53
    s_mul_i32 s53, s101, 896
    s_add_u32 s52, s52, s53
    buffer_store_dwordx4 v[124:127], v132, s[36:39], s52 offen
L_fin:
L_end:
    s_endpgm
.section .rodata,"a"
.p2align 6
.amdhsa_kernel sequential_preLN__spectral_gfnet__glu_gated_swiglu__prompt_kernel
  .amdhsa_next_free_vgpr 512
  .amdhsa_next_free_sgpr 102
  .amdhsa_accum_offset 256
  .amdhsa_group_segment_fixed_size 0
  .amdhsa_kernarg_size 80
  .amdhsa_user_sgpr_count 2
  .amdhsa_user_sgpr_kernarg_segment_ptr 1
  .amdhsa_system_sgpr_workgroup_id_x 1
  .amdhsa_float_denorm_mode_32 3
.end_amdhsa_kernel
```
